```python
import torch

def _softmax(x, axis=-1):
    return torch.softmax(x, dim=axis)
def _gelu(x):
    return torch.nn.functional.gelu(x, approximate="tanh")
def _silu(x):
    return torch.nn.functional.silu(x)
def _sigmoid(x):
    return torch.sigmoid(x)
def _layernorm(x, axis=-1, eps=1e-5):
    m = x.mean(dim=axis, keepdim=True)
    v = x.var(dim=axis, keepdim=True, unbiased=False)
    return (x - m) / torch.sqrt(v + eps)
def _scatter_add(tgt, idx, src, axis=0):
    return tgt.clone().index_add_(axis, idx, src)
def _segment_sum(src, seg, n):
    out = torch.zeros((n,) + src.shape[1:], dtype=src.dtype)
    return out.index_add_(0, seg, src)
def _pad(x, pw):
    flat = tuple(v for pair in reversed(pw) for v in pair)
    return torch.nn.functional.pad(x, flat)

kernel_name = 'recurrent_scan__ssm_conv_h3__moe_arch_mod__prompt'

def setup_inputs():

    _w = (lambda a: (lambda t: t.to(torch.bfloat16) if t.is_floating_point() else t)(torch.as_tensor(a)))
    def _A_setup():
        B, S, D = 1, 2048, 1024
        ks = 4
        return {
            "q": _w((lambda *s: torch.randn(*s, dtype=torch.bfloat16) * 0.05)(B, S, D)),
            "k": _w((lambda *s: torch.randn(*s, dtype=torch.bfloat16) * 0.2)(B, S, D)),
            "v": _w((lambda *s: torch.randn(*s, dtype=torch.bfloat16) * 0.2)(B, S, D)),
            "shift_k": _w((lambda *s: torch.randn(*s, dtype=torch.bfloat16) * 0.2)(D, ks) * 0.5),
            "ssm_k": _w((lambda *s: torch.randn(*s, dtype=torch.bfloat16) * 0.2)(D, S) * (1.0 / S ** 0.5)),
            "ssm_D": _w((lambda *s: torch.randn(*s, dtype=torch.bfloat16) * 0.2)(D)),
        }
    _A_in = _A_setup()

    def _B_setup():
        B, S, D, F, C = 1, 2048, 1024, 3584, 2
        return {
            "x": _w((lambda *s: torch.randn(*s, dtype=torch.bfloat16) * 0.05)(B, S, D)),
            "w_r": _w((lambda *s: torch.randn(*s, dtype=torch.bfloat16) * 0.2)(D)),
            "w_gate": _w((lambda *s: torch.randn(*s, dtype=torch.bfloat16) * 0.1)(D, F)),
            "w_up": _w((lambda *s: torch.randn(*s, dtype=torch.bfloat16) * 0.1)(D, F)),
            "w_down": _w((lambda *s: torch.randn(*s, dtype=torch.bfloat16) * 0.1)(F, D)),
        }
    _B_in = _B_setup()

    return {
        "A_q": _A_in["q"],
        "A_k": _A_in["k"],
        "A_v": _A_in["v"],
        "A_shift_k": _A_in["shift_k"],
        "A_ssm_k": _A_in["ssm_k"],
        "A_ssm_D": _A_in["ssm_D"],
        "B_x": _B_in["x"],
        "B_w_r": _B_in["w_r"],
        "B_w_gate": _B_in["w_gate"],
        "B_w_up": _B_in["w_up"],
        "B_w_down": _B_in["w_down"],
    }

def reference(A_q, A_k, A_v, A_shift_k, A_ssm_k, A_ssm_D, B_x, B_w_r, B_w_gate, B_w_up, B_w_down):
    def _A_ref(q, k, v, shift_k, ssm_k, ssm_D):
        B, S, D = q.shape
        ks = shift_k.shape[-1]
        k_pad = _pad(k, ((0, 0), (ks - 1, 0), (0, 0)))
        k_shift = torch.zeros_like(k)
        for t in range(ks):
            k_shift = k_shift + k_pad[:, t:t + S, :] * shift_k[:, ks - 1 - t][None, None, :]
        kv = k_shift * v
        L = 2 * S
        kv_pad = _pad(kv, ((0, 0), (0, S), (0, 0)))
        kf_pad = _pad(ssm_k, ((0, 0), (0, S)))
        kv_f = (lambda x, axes=(-2,-1): torch.fft.rfft2(x.float(), dim=axes))(kv_pad[:, None, :, :], axes=(1, 2))
        kf_f = (lambda x, axes=(-2,-1): torch.fft.rfft2(x.float(), dim=axes))(kf_pad[:, None, :], axes=(1, 2))
        kf_f = (lambda x, *d: x.permute(*d))(kf_f, 1, 2, 0)
        y_f = kv_f * kf_f[None, :, :, :]
        y = (lambda x, s, axes=(-2,-1): torch.fft.irfft2(x, s=s, dim=axes).to(torch.bfloat16))(y_f, (1, L), axes=(1, 2))[:, 0, :S, :]
        y = y + kv * ssm_D[None, None, :]
        return q * y

    def _B_ref(x, w_r, w_gate, w_up, w_down):
        B, S, D = x.shape
        C = 2
        r = x @ w_r
        idx = torch.argsort(-r, axis=-1)[:, :C]
        idx_e = (lambda x, n, axis: torch.repeat_interleave(x, n, dim=axis))(idx.reshape(B, C, 1), D, axis=2)
        x_sel = (lambda x, i, axis: torch.take_along_dim(x, i, dim=axis))(x, idx_e, axis=1)
        g = _silu(x_sel @ w_gate)
        u = x_sel @ w_up
        y = (g * u) @ w_down
        r_sel = _sigmoid((lambda x, i, axis: torch.take_along_dim(x, i, dim=axis))(r, idx, axis=1))
        y = y * r_sel.reshape(B, C, 1)
        b_off = (torch.arange(B) * S).reshape(B, 1)
        flat_idx = (idx + b_off).reshape(B * C)
        zero = (x * 0.0).reshape(B * S, D)
        upd = _scatter_add(zero, flat_idx, y.reshape(B * C, D), axis=0)
        return x + upd.reshape(B, S, D)

    x = A_q
    xn = _layernorm(x, axis=-1)
    s = _A_ref(xn, A_k, A_v, A_shift_k, A_ssm_k, A_ssm_D)
    g = _silu(_B_ref(xn, B_w_r, B_w_gate, B_w_up, B_w_down))
    return x + s * g
```

```asm
; @launch grid=(256,1,1) block=(256,1,1) lds=140544
.amdgcn_target "amdgcn-amd-amdhsa--gfx950"
.text
.globl recurrent_scan__ssm_conv_h3__moe_arch_mod__prompt_kernel
.p2align 8
.type recurrent_scan__ssm_conv_h3__moe_arch_mod__prompt_kernel,@function
recurrent_scan__ssm_conv_h3__moe_arch_mod__prompt_kernel:
    s_cmp_ge_u32 s2, 256
    s_cbranch_scc1 LEND
    s_load_dwordx2 s[4:5], s[0:1], 0
    s_load_dwordx2 s[28:29], s[0:1], 56
    s_load_dwordx2 s[8:9], s[0:1], 8
    s_load_dwordx2 s[12:13], s[0:1], 16
    s_load_dwordx2 s[16:17], s[0:1], 24
    s_load_dwordx2 s[48:49], s[0:1], 104
    s_load_dwordx2 s[20:21], s[0:1], 32
    s_load_dwordx2 s[24:25], s[0:1], 40
    s_load_dwordx2 s[32:33], s[0:1], 64
    s_load_dwordx2 s[36:37], s[0:1], 72
    s_load_dwordx2 s[40:41], s[0:1], 80
    s_load_dwordx2 s[44:45], s[0:1], 88
    s_mov_b32 s6, 4194304
    s_mov_b32 s7, 0x20000
    s_mov_b32 s10, 4194304
    s_mov_b32 s11, 0x20000
    s_mov_b32 s14, 4194304
    s_mov_b32 s15, 0x20000
    s_mov_b32 s18, 8192
    s_mov_b32 s19, 0x20000
    s_mov_b32 s22, 4194304
    s_mov_b32 s23, 0x20000
    s_mov_b32 s26, 2048
    s_mov_b32 s27, 0x20000
    s_mov_b32 s30, 2048
    s_mov_b32 s31, 0x20000
    s_mov_b32 s34, 7340032
    s_mov_b32 s35, 0x20000
    s_mov_b32 s38, 7340032
    s_mov_b32 s39, 0x20000
    s_mov_b32 s42, 7340032
    s_mov_b32 s43, 0x20000
    s_mov_b32 s46, 4194304
    s_mov_b32 s47, 0x20000
    s_mov_b32 s50, 268435456
    s_mov_b32 s51, 0x20000
    s_mov_b32 s65, 4096
    s_mov_b32 s66, 8192
    s_mov_b32 s67, 12288
    s_mov_b32 s68, 16384
    s_mov_b32 s69, 20480
    s_mov_b32 s70, 24576
    s_mov_b32 s71, 28672
    s_and_b32 s56, s2, 7
    s_lshr_b32 s57, s2, 3
    v_lshrrev_b32 v2, 6, v0
    v_and_b32 v1, 63, v0
    v_readfirstlane_b32 s58, v2
    s_getreg_b32 s61, hwreg(HW_REG_XCC_ID, 0, 4)
    v_lshlrev_b32 v5, 4, v1
    s_mov_b32 s60, 1
    v_mov_b32 v14, 0xff
    v_mov_b32 v15, 0
    s_lshl_b32 s63, s57, 2
    s_add_u32 s63, s63, s58
    s_lshl_b32 s72, s63, 15
    s_lshl_b32 s73, s56, 8
    s_add_u32 s72, s72, s73
    v_lshl_add_u32 v3, v1, 2, s72
    v_subrev_u32 v4, 6144, v3
    s_cmp_eq_u32 s63, 0
    s_cselect_b32 s73, 0x80000000, 0
    v_or_b32 v4, s73, v4
    v_and_b32 v6, 0x807fffff, v4
    v_add_u32 v2, 4096, v6
    s_waitcnt lgkmcnt(0)
    s_mov_b32 s74, 0x4A0000
    s_load_dword s59, s[48:49], s74
    s_lshl_b32 s72, s2, 2
    s_add_u32 s72, s72, s58
    s_lshl_b32 s79, s72, 4
    s_lshl_b32 s72, s72, 12
    v_add_u32 v13, s72, v5
    buffer_load_dwordx4 v[148:151], v13, s[4:7], 0 offen offset:0 nt
    buffer_load_dwordx4 v[152:155], v13, s[4:7], 0 offen offset:1024 nt
    buffer_load_dwordx4 v[156:159], v13, s[4:7], 0 offen offset:2048 nt
    buffer_load_dwordx4 v[160:163], v13, s[4:7], 0 offen offset:3072 nt
    buffer_load_dwordx4 v[164:167], v5, s[28:31], 0 offen offset:0
    buffer_load_dwordx4 v[168:171], v5, s[28:31], 0 offen offset:1024
    buffer_load_dword v204, v6, s[8:11], 0 offen nt
    buffer_load_dword v205, v6, s[8:11], 0 offen offset:2048 nt
    buffer_load_dword v206, v2, s[8:11], 0 offen nt
    s_lshl_b32 s72, s56, 10
    v_lshl_add_u32 v4, v1, 4, s72
    buffer_load_dwordx4 v[240:243], v4, s[16:19], 0 offen
    buffer_load_dword v207, v3, s[8:11], 0 offen offset:0 nt
    buffer_load_dword v223, v3, s[12:15], 0 offen offset:0 nt
    buffer_load_dword v208, v3, s[8:11], 0 offen offset:2048 nt
    buffer_load_dword v224, v3, s[12:15], 0 offen offset:2048 nt
    buffer_load_dword v209, v3, s[8:11], s65 offen offset:0 nt
    buffer_load_dword v225, v3, s[12:15], s65 offen offset:0 nt
    buffer_load_dword v210, v3, s[8:11], s65 offen offset:2048 nt
    buffer_load_dword v226, v3, s[12:15], s65 offen offset:2048 nt
    buffer_load_dword v211, v3, s[8:11], s66 offen offset:0 nt
    buffer_load_dword v227, v3, s[12:15], s66 offen offset:0 nt
    buffer_load_dword v212, v3, s[8:11], s66 offen offset:2048 nt
    buffer_load_dword v228, v3, s[12:15], s66 offen offset:2048 nt
    buffer_load_dword v213, v3, s[8:11], s67 offen offset:0 nt
    buffer_load_dword v229, v3, s[12:15], s67 offen offset:0 nt
    buffer_load_dword v214, v3, s[8:11], s67 offen offset:2048 nt
    buffer_load_dword v230, v3, s[12:15], s67 offen offset:2048 nt
    s_mov_b64 exec, 0
    s_mov_b32 s62, s63
LPD:
    s_cmpk_eq_u32 s62, 0
    s_cbranch_scc1 LP0
    s_cmpk_eq_u32 s62, 1
    s_cbranch_scc1 LP1
    s_cmpk_eq_u32 s62, 2
    s_cbranch_scc1 LP2
    s_cmpk_eq_u32 s62, 3
    s_cbranch_scc1 LP3
    s_cmpk_eq_u32 s62, 4
    s_cbranch_scc1 LP4
    s_cmpk_eq_u32 s62, 5
    s_cbranch_scc1 LP5
    s_cmpk_eq_u32 s62, 6
    s_cbranch_scc1 LP6
    s_cmpk_eq_u32 s62, 7
    s_cbranch_scc1 LP7
    s_cmpk_eq_u32 s62, 8
    s_cbranch_scc1 LP8
    s_cmpk_eq_u32 s62, 9
    s_cbranch_scc1 LP9
    s_cmpk_eq_u32 s62, 10
    s_cbranch_scc1 LP10
    s_cmpk_eq_u32 s62, 11
    s_cbranch_scc1 LP11
    s_cmpk_eq_u32 s62, 12
    s_cbranch_scc1 LP12
    s_cmpk_eq_u32 s62, 13
    s_cbranch_scc1 LP13
    s_cmpk_eq_u32 s62, 14
    s_cbranch_scc1 LP14
    s_cmpk_eq_u32 s62, 15
    s_cbranch_scc1 LP15
    s_cmpk_eq_u32 s62, 16
    s_cbranch_scc1 LP16
    s_cmpk_eq_u32 s62, 17
    s_cbranch_scc1 LP17
    s_cmpk_eq_u32 s62, 18
    s_cbranch_scc1 LP18
    s_cmpk_eq_u32 s62, 19
    s_cbranch_scc1 LP19
    s_cmpk_eq_u32 s62, 20
    s_cbranch_scc1 LP20
    s_cmpk_eq_u32 s62, 21
    s_cbranch_scc1 LP21
    s_cmpk_eq_u32 s62, 22
    s_cbranch_scc1 LP22
    s_cmpk_eq_u32 s62, 23
    s_cbranch_scc1 LP23
    s_cmpk_eq_u32 s62, 24
    s_cbranch_scc1 LP24
    s_cmpk_eq_u32 s62, 25
    s_cbranch_scc1 LP25
    s_cmpk_eq_u32 s62, 26
    s_cbranch_scc1 LP26
    s_cmpk_eq_u32 s62, 27
    s_cbranch_scc1 LP27
    s_cmpk_eq_u32 s62, 28
    s_cbranch_scc1 LP28
    s_cmpk_eq_u32 s62, 29
    s_cbranch_scc1 LP29
LPR:
    s_addk_i32 s62, 128
    s_cmpk_lt_u32 s62, 30
    s_cbranch_scc1 LPD
    s_mov_b64 exec, -1
    buffer_load_dword v215, v3, s[8:11], s68 offen offset:0 nt
    buffer_load_dword v231, v3, s[12:15], s68 offen offset:0 nt
    buffer_load_dword v216, v3, s[8:11], s68 offen offset:2048 nt
    buffer_load_dword v232, v3, s[12:15], s68 offen offset:2048 nt
    buffer_load_dword v217, v3, s[8:11], s69 offen offset:0 nt
    buffer_load_dword v233, v3, s[12:15], s69 offen offset:0 nt
    buffer_load_dword v218, v3, s[8:11], s69 offen offset:2048 nt
    buffer_load_dword v234, v3, s[12:15], s69 offen offset:2048 nt
    buffer_load_dword v219, v3, s[8:11], s70 offen offset:0 nt
    buffer_load_dword v235, v3, s[12:15], s70 offen offset:0 nt
    buffer_load_dword v220, v3, s[8:11], s70 offen offset:2048 nt
    buffer_load_dword v236, v3, s[12:15], s70 offen offset:2048 nt
    buffer_load_dword v221, v3, s[8:11], s71 offen offset:0 nt
    buffer_load_dword v237, v3, s[12:15], s71 offen offset:0 nt
    buffer_load_dword v222, v3, s[8:11], s71 offen offset:2048 nt
    buffer_load_dword v238, v3, s[12:15], s71 offen offset:2048 nt
    s_lshl_b32 s72, s56, 7
    s_add_u32 s72, s72, s63
    s_lshl_b32 s78, s72, 12
    s_lshl_b32 s52, s72, 1
    s_lshl_b32 s72, s58, 4
    s_lshl_b64 s[0:1], 0xffff, s72
    s_mov_b32 s53, 0x3f803f80
    v_add_u32 v12, s78, v5
    v_subrev_u32 v6, 8, v12
    v_cmp_eq_u32 vcc, 0, v1
    v_mov_b32 v7, 0x80000000
    s_nop 0
    v_cndmask_b32 v7, v6, v7, vcc
    v_mov_b32 v244, 0
    v_mov_b32 v245, 0
    s_mul_i32 s72, s58, 4608
    s_add_u32 s72, s72, 66560
    v_lshl_add_u32 v4, v1, 3, s72
    ds_write_b64 v4, v[244:245]
    s_mul_i32 s73, s58, 16640
    v_and_b32 v4, 3, v1
    v_bfe_u32 v6, v1, 2, 2
    v_mul_u32_u24 v6, 4160, v6
    v_lshl_add_u32 v4, v4, 3, v6
    v_add_u32 v4, s73, v4
    ds_write_b64 v4, v[244:245]
    v_mov_b32 v4, 140320
    ds_write_b32 v4, v244
    s_waitcnt vmcnt(38)
    v_dot2_f32_bf16 v112, v148, s53, 0
    v_dot2_f32_bf16 v113, v148, v148, 0
    v_dot2_f32_bf16 v114, v156, s53, 0
    v_dot2_f32_bf16 v115, v156, v156, 0
    v_dot2_f32_bf16 v112, v149, s53, v112
    v_dot2_f32_bf16 v113, v149, v149, v113
    v_dot2_f32_bf16 v114, v157, s53, v114
    v_dot2_f32_bf16 v115, v157, v157, v115
    v_dot2_f32_bf16 v112, v150, s53, v112
    v_dot2_f32_bf16 v113, v150, v150, v113
    v_dot2_f32_bf16 v114, v158, s53, v114
    v_dot2_f32_bf16 v115, v158, v158, v115
    v_dot2_f32_bf16 v112, v151, s53, v112
    v_dot2_f32_bf16 v113, v151, v151, v113
    v_dot2_f32_bf16 v114, v159, s53, v114
    v_dot2_f32_bf16 v115, v159, v159, v115
    v_dot2_f32_bf16 v112, v152, s53, v112
    v_dot2_f32_bf16 v113, v152, v152, v113
    v_dot2_f32_bf16 v114, v160, s53, v114
    v_dot2_f32_bf16 v115, v160, v160, v115
    v_dot2_f32_bf16 v112, v153, s53, v112
    v_dot2_f32_bf16 v113, v153, v153, v113
    v_dot2_f32_bf16 v114, v161, s53, v114
    v_dot2_f32_bf16 v115, v161, v161, v115
    v_dot2_f32_bf16 v112, v154, s53, v112
    v_dot2_f32_bf16 v113, v154, v154, v113
    v_dot2_f32_bf16 v114, v162, s53, v114
    v_dot2_f32_bf16 v115, v162, v162, v115
    v_dot2_f32_bf16 v112, v155, s53, v112
    v_dot2_f32_bf16 v113, v155, v155, v113
    v_dot2_f32_bf16 v114, v163, s53, v114
LP0:
    s_cbranch_execz LPR
    v_dot2_f32_bf16 v115, v163, v163, v115
    buffer_load_dwordx4 v[182:185], v12, s[20:23], 0 offen offset:0 nt
    buffer_load_dwordx2 v[180:181], v7, s[20:23], 0 offen nt
    buffer_load_dwordx4 v[188:191], v12, s[20:23], 0 offen offset:1024 nt
    buffer_load_dwordx2 v[186:187], v12, s[20:23], 0 offen offset:1016 nt
    v_add_f32_dpp v112, v112, v112 quad_perm:[1,0,3,2] row_mask:0xf bank_mask:0xf
    v_add_f32_dpp v113, v113, v113 quad_perm:[1,0,3,2] row_mask:0xf bank_mask:0xf
    v_add_f32_dpp v114, v114, v114 quad_perm:[1,0,3,2] row_mask:0xf bank_mask:0xf
    v_add_f32_dpp v115, v115, v115 quad_perm:[1,0,3,2] row_mask:0xf bank_mask:0xf
    v_add_f32_dpp v112, v112, v112 quad_perm:[2,3,0,1] row_mask:0xf bank_mask:0xf
    v_add_f32_dpp v113, v113, v113 quad_perm:[2,3,0,1] row_mask:0xf bank_mask:0xf
    v_add_f32_dpp v114, v114, v114 quad_perm:[2,3,0,1] row_mask:0xf bank_mask:0xf
    v_add_f32_dpp v115, v115, v115 quad_perm:[2,3,0,1] row_mask:0xf bank_mask:0xf
    v_add_f32_dpp v112, v112, v112 row_half_mirror row_mask:0xf bank_mask:0xf
    v_add_f32_dpp v113, v113, v113 row_half_mirror row_mask:0xf bank_mask:0xf
    v_add_f32_dpp v114, v114, v114 row_half_mirror row_mask:0xf bank_mask:0xf
    v_add_f32_dpp v115, v115, v115 row_half_mirror row_mask:0xf bank_mask:0xf
    v_add_f32_dpp v112, v112, v112 row_mirror row_mask:0xf bank_mask:0xf
    v_add_f32_dpp v113, v113, v113 row_mirror row_mask:0xf bank_mask:0xf
    v_add_f32_dpp v114, v114, v114 row_mirror row_mask:0xf bank_mask:0xf
    v_add_f32_dpp v115, v115, v115 row_mirror row_mask:0xf bank_mask:0xf
    v_add_f32_dpp v112, v112, v112 row_bcast:15 row_mask:0xa bank_mask:0xf
    v_add_f32_dpp v113, v113, v113 row_bcast:15 row_mask:0xa bank_mask:0xf
    v_add_f32_dpp v114, v114, v114 row_bcast:15 row_mask:0xa bank_mask:0xf
    v_add_f32_dpp v115, v115, v115 row_bcast:15 row_mask:0xa bank_mask:0xf
    v_add_f32_dpp v112, v112, v112 row_bcast:31 row_mask:0xc bank_mask:0xf
    v_add_f32_dpp v113, v113, v113 row_bcast:31 row_mask:0xc bank_mask:0xf
    v_add_f32_dpp v114, v114, v114 row_bcast:31 row_mask:0xc bank_mask:0xf
    v_add_f32_dpp v115, v115, v115 row_bcast:31 row_mask:0xc bank_mask:0xf
    v_readlane_b32 s72, v112, 63
    v_readlane_b32 s73, v113, 63
    v_readlane_b32 s74, v114, 63
    v_readlane_b32 s75, v115, 63
    v_mov_b32 v120, 0x3a800000
    v_mul_f32 v116, s72, v120
    v_mul_f32 v122, s73, v120
    v_fma_f32 v122, -v116, v116, v122
    v_max_f32 v122, 0, v122
    v_cvt_pk_bf16_f32 v122, v122, v122
    v_and_b32 v122, 0xffff0000, v122
    v_add_f32 v122, 0x3727c5ac, v122
    v_cvt_pk_bf16_f32 v122, v122, v122
    v_and_b32 v122, 0xffff0000, v122
    v_sqrt_f32 v122, v122
    s_nop 0
    v_cvt_pk_bf16_f32 v128, v116, v122
    v_lshlrev_b32 v116, 16, v128
    v_and_b32 v122, 0xffff0000, v128
    v_rcp_f32 v122, v122
    v_mul_f32 v118, s74, v120
    v_mul_f32 v124, s75, v120
    v_fma_f32 v124, -v118, v118, v124
    v_max_f32 v124, 0, v124
    v_cvt_pk_bf16_f32 v124, v124, v124
    v_and_b32 v124, 0xffff0000, v124
    v_add_f32 v124, 0x3727c5ac, v124
    v_cvt_pk_bf16_f32 v124, v124, v124
    v_and_b32 v124, 0xffff0000, v124
    v_sqrt_f32 v124, v124
    s_nop 0
    v_cvt_pk_bf16_f32 v129, v118, v124
    v_lshlrev_b32 v118, 16, v129
    v_and_b32 v124, 0xffff0000, v129
    v_rcp_f32 v124, v124
    s_waitcnt vmcnt(40)
    v_lshlrev_b32 v96, 16, v148
    v_and_b32 v97, 0xffff0000, v148
    v_pk_add_f32 v[96:97], v[96:97], v[116:117] op_sel_hi:[1,0] neg_lo:[0,1] neg_hi:[0,1]
    v_cvt_pk_bf16_f32 v97, v96, v97
    v_lshlrev_b32 v96, 16, v97
    v_and_b32 v97, 0xffff0000, v97
    v_pk_mul_f32 v[96:97], v[96:97], v[122:123] op_sel_hi:[1,0]
LP1:
    s_cbranch_execz LPR
    v_cvt_pk_bf16_f32 v96, v96, v97
    v_dot2_f32_bf16 v112, v96, v164, 0
    v_lshlrev_b32 v98, 16, v156
    v_and_b32 v99, 0xffff0000, v156
    v_pk_add_f32 v[98:99], v[98:99], v[118:119] op_sel_hi:[1,0] neg_lo:[0,1] neg_hi:[0,1]
    v_cvt_pk_bf16_f32 v99, v98, v99
    v_lshlrev_b32 v98, 16, v99
    v_and_b32 v99, 0xffff0000, v99
    v_pk_mul_f32 v[98:99], v[98:99], v[124:125] op_sel_hi:[1,0]
    v_cvt_pk_bf16_f32 v98, v98, v99
    v_dot2_f32_bf16 v114, v98, v164, 0
    v_lshlrev_b32 v96, 16, v149
    v_and_b32 v97, 0xffff0000, v149
    v_pk_add_f32 v[96:97], v[96:97], v[116:117] op_sel_hi:[1,0] neg_lo:[0,1] neg_hi:[0,1]
    v_cvt_pk_bf16_f32 v97, v96, v97
    v_lshlrev_b32 v96, 16, v97
    v_and_b32 v97, 0xffff0000, v97
    v_pk_mul_f32 v[96:97], v[96:97], v[122:123] op_sel_hi:[1,0]
    v_cvt_pk_bf16_f32 v96, v96, v97
    v_dot2_f32_bf16 v112, v96, v165, v112
    v_lshlrev_b32 v98, 16, v157
    v_and_b32 v99, 0xffff0000, v157
    v_pk_add_f32 v[98:99], v[98:99], v[118:119] op_sel_hi:[1,0] neg_lo:[0,1] neg_hi:[0,1]
    v_cvt_pk_bf16_f32 v99, v98, v99
    v_lshlrev_b32 v98, 16, v99
    v_and_b32 v99, 0xffff0000, v99
    v_pk_mul_f32 v[98:99], v[98:99], v[124:125] op_sel_hi:[1,0]
    v_cvt_pk_bf16_f32 v98, v98, v99
    v_dot2_f32_bf16 v114, v98, v165, v114
    v_lshlrev_b32 v96, 16, v150
    v_and_b32 v97, 0xffff0000, v150
    v_pk_add_f32 v[96:97], v[96:97], v[116:117] op_sel_hi:[1,0] neg_lo:[0,1] neg_hi:[0,1]
    v_cvt_pk_bf16_f32 v97, v96, v97
    v_lshlrev_b32 v96, 16, v97
    v_and_b32 v97, 0xffff0000, v97
    v_pk_mul_f32 v[96:97], v[96:97], v[122:123] op_sel_hi:[1,0]
    v_cvt_pk_bf16_f32 v96, v96, v97
    v_dot2_f32_bf16 v112, v96, v166, v112
    v_lshlrev_b32 v98, 16, v158
    v_and_b32 v99, 0xffff0000, v158
    v_pk_add_f32 v[98:99], v[98:99], v[118:119] op_sel_hi:[1,0] neg_lo:[0,1] neg_hi:[0,1]
    v_cvt_pk_bf16_f32 v99, v98, v99
    v_lshlrev_b32 v98, 16, v99
    v_and_b32 v99, 0xffff0000, v99
    v_pk_mul_f32 v[98:99], v[98:99], v[124:125] op_sel_hi:[1,0]
    v_cvt_pk_bf16_f32 v98, v98, v99
    v_dot2_f32_bf16 v114, v98, v166, v114
    buffer_load_dwordx4 v[194:197], v12, s[20:23], 0 offen offset:2048 nt
    buffer_load_dwordx2 v[192:193], v12, s[20:23], 0 offen offset:2040 nt
    v_lshlrev_b32 v96, 16, v151
    v_and_b32 v97, 0xffff0000, v151
    v_pk_add_f32 v[96:97], v[96:97], v[116:117] op_sel_hi:[1,0] neg_lo:[0,1] neg_hi:[0,1]
    v_cvt_pk_bf16_f32 v97, v96, v97
    v_lshlrev_b32 v96, 16, v97
    v_and_b32 v97, 0xffff0000, v97
    v_pk_mul_f32 v[96:97], v[96:97], v[122:123] op_sel_hi:[1,0]
    v_cvt_pk_bf16_f32 v96, v96, v97
    v_dot2_f32_bf16 v112, v96, v167, v112
    v_lshlrev_b32 v98, 16, v159
    v_and_b32 v99, 0xffff0000, v159
    v_pk_add_f32 v[98:99], v[98:99], v[118:119] op_sel_hi:[1,0] neg_lo:[0,1] neg_hi:[0,1]
    v_cvt_pk_bf16_f32 v99, v98, v99
    v_lshlrev_b32 v98, 16, v99
    v_and_b32 v99, 0xffff0000, v99
    v_pk_mul_f32 v[98:99], v[98:99], v[124:125] op_sel_hi:[1,0]
    v_cvt_pk_bf16_f32 v98, v98, v99
    v_dot2_f32_bf16 v114, v98, v167, v114
    v_lshlrev_b32 v96, 16, v152
    v_and_b32 v97, 0xffff0000, v152
    v_pk_add_f32 v[96:97], v[96:97], v[116:117] op_sel_hi:[1,0] neg_lo:[0,1] neg_hi:[0,1]
    v_cvt_pk_bf16_f32 v97, v96, v97
LP2:
    s_cbranch_execz LPR
    v_lshlrev_b32 v96, 16, v97
    v_and_b32 v97, 0xffff0000, v97
    v_pk_mul_f32 v[96:97], v[96:97], v[122:123] op_sel_hi:[1,0]
    v_cvt_pk_bf16_f32 v96, v96, v97
    v_dot2_f32_bf16 v112, v96, v168, v112
    v_lshlrev_b32 v98, 16, v160
    v_and_b32 v99, 0xffff0000, v160
    v_pk_add_f32 v[98:99], v[98:99], v[118:119] op_sel_hi:[1,0] neg_lo:[0,1] neg_hi:[0,1]
    v_cvt_pk_bf16_f32 v99, v98, v99
    v_lshlrev_b32 v98, 16, v99
    v_and_b32 v99, 0xffff0000, v99
    v_pk_mul_f32 v[98:99], v[98:99], v[124:125] op_sel_hi:[1,0]
    v_cvt_pk_bf16_f32 v98, v98, v99
    v_dot2_f32_bf16 v114, v98, v168, v114
    v_lshlrev_b32 v96, 16, v153
    v_and_b32 v97, 0xffff0000, v153
    v_pk_add_f32 v[96:97], v[96:97], v[116:117] op_sel_hi:[1,0] neg_lo:[0,1] neg_hi:[0,1]
    v_cvt_pk_bf16_f32 v97, v96, v97
    v_lshlrev_b32 v96, 16, v97
    v_and_b32 v97, 0xffff0000, v97
    v_pk_mul_f32 v[96:97], v[96:97], v[122:123] op_sel_hi:[1,0]
    v_cvt_pk_bf16_f32 v96, v96, v97
    v_dot2_f32_bf16 v112, v96, v169, v112
    v_lshlrev_b32 v98, 16, v161
    v_and_b32 v99, 0xffff0000, v161
    v_pk_add_f32 v[98:99], v[98:99], v[118:119] op_sel_hi:[1,0] neg_lo:[0,1] neg_hi:[0,1]
    v_cvt_pk_bf16_f32 v99, v98, v99
    v_lshlrev_b32 v98, 16, v99
    v_and_b32 v99, 0xffff0000, v99
    v_pk_mul_f32 v[98:99], v[98:99], v[124:125] op_sel_hi:[1,0]
    v_cvt_pk_bf16_f32 v98, v98, v99
    v_dot2_f32_bf16 v114, v98, v169, v114
    buffer_load_dwordx4 v[200:203], v12, s[20:23], 0 offen offset:3072 nt
    buffer_load_dwordx2 v[198:199], v12, s[20:23], 0 offen offset:3064 nt
    buffer_load_ushort v11, off, s[24:27], s52
    v_lshlrev_b32 v96, 16, v154
    v_and_b32 v97, 0xffff0000, v154
    v_pk_add_f32 v[96:97], v[96:97], v[116:117] op_sel_hi:[1,0] neg_lo:[0,1] neg_hi:[0,1]
    v_cvt_pk_bf16_f32 v97, v96, v97
    v_lshlrev_b32 v96, 16, v97
    v_and_b32 v97, 0xffff0000, v97
    v_pk_mul_f32 v[96:97], v[96:97], v[122:123] op_sel_hi:[1,0]
    v_cvt_pk_bf16_f32 v96, v96, v97
    v_dot2_f32_bf16 v112, v96, v170, v112
    v_lshlrev_b32 v98, 16, v162
    v_and_b32 v99, 0xffff0000, v162
    v_pk_add_f32 v[98:99], v[98:99], v[118:119] op_sel_hi:[1,0] neg_lo:[0,1] neg_hi:[0,1]
    v_cvt_pk_bf16_f32 v99, v98, v99
    v_lshlrev_b32 v98, 16, v99
    v_and_b32 v99, 0xffff0000, v99
    v_pk_mul_f32 v[98:99], v[98:99], v[124:125] op_sel_hi:[1,0]
    v_cvt_pk_bf16_f32 v98, v98, v99
    v_dot2_f32_bf16 v114, v98, v170, v114
    v_lshlrev_b32 v96, 16, v155
    v_and_b32 v97, 0xffff0000, v155
    v_pk_add_f32 v[96:97], v[96:97], v[116:117] op_sel_hi:[1,0] neg_lo:[0,1] neg_hi:[0,1]
    v_cvt_pk_bf16_f32 v97, v96, v97
    v_lshlrev_b32 v96, 16, v97
    v_and_b32 v97, 0xffff0000, v97
    v_pk_mul_f32 v[96:97], v[96:97], v[122:123] op_sel_hi:[1,0]
    v_cvt_pk_bf16_f32 v96, v96, v97
    v_dot2_f32_bf16 v112, v96, v171, v112
    v_lshlrev_b32 v98, 16, v163
    v_and_b32 v99, 0xffff0000, v163
    v_pk_add_f32 v[98:99], v[98:99], v[118:119] op_sel_hi:[1,0] neg_lo:[0,1] neg_hi:[0,1]
    v_cvt_pk_bf16_f32 v99, v98, v99
    v_lshlrev_b32 v98, 16, v99
    v_and_b32 v99, 0xffff0000, v99
    v_pk_mul_f32 v[98:99], v[98:99], v[124:125] op_sel_hi:[1,0]
    v_cvt_pk_bf16_f32 v98, v98, v99
    v_dot2_f32_bf16 v114, v98, v171, v114
LP3:
    s_cbranch_execz LPR
    s_waitcnt lgkmcnt(0)
    s_add_u32 s59, s59, 0x01010101
    v_mov_b32 v131, s59
    s_add_u32 s79, s79, 4194304
    v_mov_b32 v4, s79
    v_add_f32_dpp v112, v112, v112 quad_perm:[1,0,3,2] row_mask:0xf bank_mask:0xf
    v_add_f32_dpp v114, v114, v114 quad_perm:[1,0,3,2] row_mask:0xf bank_mask:0xf
    s_nop 0
    v_add_f32_dpp v112, v112, v112 quad_perm:[2,3,0,1] row_mask:0xf bank_mask:0xf
    v_add_f32_dpp v114, v114, v114 quad_perm:[2,3,0,1] row_mask:0xf bank_mask:0xf
    s_nop 0
    v_add_f32_dpp v112, v112, v112 row_half_mirror row_mask:0xf bank_mask:0xf
    v_add_f32_dpp v114, v114, v114 row_half_mirror row_mask:0xf bank_mask:0xf
    s_nop 0
    v_add_f32_dpp v112, v112, v112 row_mirror row_mask:0xf bank_mask:0xf
    v_add_f32_dpp v114, v114, v114 row_mirror row_mask:0xf bank_mask:0xf
    s_nop 0
    v_add_f32_dpp v112, v112, v112 row_bcast:15 row_mask:0xa bank_mask:0xf
    v_add_f32_dpp v114, v114, v114 row_bcast:15 row_mask:0xa bank_mask:0xf
    s_nop 0
    v_add_f32_dpp v112, v112, v112 row_bcast:31 row_mask:0xc bank_mask:0xf
    v_add_f32_dpp v114, v114, v114 row_bcast:31 row_mask:0xc bank_mask:0xf
    v_cvt_pk_bf16_f32 v130, v112, v114
    v_pk_ashrrev_i16 v112, 15, v130 op_sel_hi:[0,1]
    v_or_b32 v112, 0x80008000, v112
    v_xor_b32 v130, v112, v130
    s_mov_b32 exec_lo, 0
    s_mov_b32 exec_hi, 0x80000000
    buffer_store_dwordx4 v[128:131], v4, s[48:51], 0 offen sc0 sc1
    s_mov_b64 exec, -1
    s_waitcnt vmcnt(42)
    v_lshlrev_b32 v88, 16, v240
    v_and_b32 v90, 0xffff0000, v240
    v_lshlrev_b32 v92, 16, v241
    v_and_b32 v94, 0xffff0000, v241
    v_lshlrev_b32 v89, 16, v242
    v_and_b32 v91, 0xffff0000, v242
    v_lshlrev_b32 v93, 16, v243
    v_and_b32 v95, 0xffff0000, v243
    v_lshlrev_b32 v96, 16, v204
    v_and_b32 v97, 0xffff0000, v204
    v_lshlrev_b32 v98, 16, v205
    v_and_b32 v99, 0xffff0000, v205
    v_lshlrev_b32 v100, 16, v206
    v_and_b32 v101, 0xffff0000, v206
    s_waitcnt vmcnt(34)
    v_lshlrev_b32 v102, 16, v207
    v_and_b32 v103, 0xffff0000, v207
    v_lshlrev_b32 v134, 16, v223
    v_and_b32 v135, 0xffff0000, v223
    v_pk_mul_f32 v[136:137], v[96:97], v[94:95]
    v_pk_fma_f32 v[136:137], v[98:99], v[92:93], v[136:137]
    v_pk_fma_f32 v[136:137], v[100:101], v[90:91], v[136:137]
    v_pk_fma_f32 v[136:137], v[102:103], v[88:89], v[136:137]
    v_pk_mul_f32 v[136:137], v[136:137], v[134:135]
    v_lshlrev_b32 v104, 16, v208
    v_and_b32 v105, 0xffff0000, v208
    v_lshlrev_b32 v134, 16, v224
    v_and_b32 v135, 0xffff0000, v224
    v_pk_mul_f32 v[138:139], v[98:99], v[94:95]
    v_pk_fma_f32 v[138:139], v[100:101], v[92:93], v[138:139]
    v_pk_fma_f32 v[138:139], v[102:103], v[90:91], v[138:139]
    v_pk_fma_f32 v[138:139], v[104:105], v[88:89], v[138:139]
    v_pk_mul_f32 v[138:139], v[138:139], v[134:135]
    v_cvt_pk_bf16_f32 v19, v138, v136
    v_cvt_pk_bf16_f32 v27, v139, v137
    v_lshlrev_b32 v106, 16, v209
    v_and_b32 v107, 0xffff0000, v209
    v_lshlrev_b32 v134, 16, v225
    v_and_b32 v135, 0xffff0000, v225
    v_pk_mul_f32 v[136:137], v[100:101], v[94:95]
    v_pk_fma_f32 v[136:137], v[102:103], v[92:93], v[136:137]
    v_pk_fma_f32 v[136:137], v[104:105], v[90:91], v[136:137]
    v_pk_fma_f32 v[136:137], v[106:107], v[88:89], v[136:137]
    v_pk_mul_f32 v[136:137], v[136:137], v[134:135]
    v_lshlrev_b32 v108, 16, v210
    v_and_b32 v109, 0xffff0000, v210
LP4:
    s_cbranch_execz LPR
    v_lshlrev_b32 v134, 16, v226
    v_and_b32 v135, 0xffff0000, v226
    v_pk_mul_f32 v[138:139], v[102:103], v[94:95]
    v_pk_fma_f32 v[138:139], v[104:105], v[92:93], v[138:139]
    v_pk_fma_f32 v[138:139], v[106:107], v[90:91], v[138:139]
    v_pk_fma_f32 v[138:139], v[108:109], v[88:89], v[138:139]
    v_pk_mul_f32 v[138:139], v[138:139], v[134:135]
    v_cvt_pk_bf16_f32 v18, v138, v136
    v_cvt_pk_bf16_f32 v26, v139, v137
    s_waitcnt vmcnt(26)
    v_lshlrev_b32 v110, 16, v211
    v_and_b32 v111, 0xffff0000, v211
    v_lshlrev_b32 v134, 16, v227
    v_and_b32 v135, 0xffff0000, v227
    v_pk_mul_f32 v[136:137], v[104:105], v[94:95]
    v_pk_fma_f32 v[136:137], v[106:107], v[92:93], v[136:137]
    v_pk_fma_f32 v[136:137], v[108:109], v[90:91], v[136:137]
    v_pk_fma_f32 v[136:137], v[110:111], v[88:89], v[136:137]
    v_pk_mul_f32 v[136:137], v[136:137], v[134:135]
    v_lshlrev_b32 v112, 16, v212
    v_and_b32 v113, 0xffff0000, v212
    v_lshlrev_b32 v134, 16, v228
    v_and_b32 v135, 0xffff0000, v228
    v_pk_mul_f32 v[138:139], v[106:107], v[94:95]
    v_pk_fma_f32 v[138:139], v[108:109], v[92:93], v[138:139]
    v_pk_fma_f32 v[138:139], v[110:111], v[90:91], v[138:139]
    v_pk_fma_f32 v[138:139], v[112:113], v[88:89], v[138:139]
    v_pk_mul_f32 v[138:139], v[138:139], v[134:135]
    v_cvt_pk_bf16_f32 v17, v138, v136
    v_cvt_pk_bf16_f32 v25, v139, v137
    v_lshlrev_b32 v114, 16, v213
    v_and_b32 v115, 0xffff0000, v213
    v_lshlrev_b32 v134, 16, v229
    v_and_b32 v135, 0xffff0000, v229
    v_pk_mul_f32 v[136:137], v[108:109], v[94:95]
    v_pk_fma_f32 v[136:137], v[110:111], v[92:93], v[136:137]
    v_pk_fma_f32 v[136:137], v[112:113], v[90:91], v[136:137]
    v_pk_fma_f32 v[136:137], v[114:115], v[88:89], v[136:137]
    v_pk_mul_f32 v[136:137], v[136:137], v[134:135]
    v_lshlrev_b32 v116, 16, v214
    v_and_b32 v117, 0xffff0000, v214
    v_lshlrev_b32 v134, 16, v230
    v_and_b32 v135, 0xffff0000, v230
    v_pk_mul_f32 v[138:139], v[110:111], v[94:95]
    v_pk_fma_f32 v[138:139], v[112:113], v[92:93], v[138:139]
    v_pk_fma_f32 v[138:139], v[114:115], v[90:91], v[138:139]
    v_pk_fma_f32 v[138:139], v[116:117], v[88:89], v[138:139]
    v_pk_mul_f32 v[138:139], v[138:139], v[134:135]
    v_cvt_pk_bf16_f32 v16, v138, v136
    v_cvt_pk_bf16_f32 v24, v139, v137
    s_waitcnt vmcnt(18)
    v_lshlrev_b32 v118, 16, v215
    v_and_b32 v119, 0xffff0000, v215
    v_lshlrev_b32 v134, 16, v231
    v_and_b32 v135, 0xffff0000, v231
    v_pk_mul_f32 v[136:137], v[112:113], v[94:95]
    v_pk_fma_f32 v[136:137], v[114:115], v[92:93], v[136:137]
    v_pk_fma_f32 v[136:137], v[116:117], v[90:91], v[136:137]
    v_pk_fma_f32 v[136:137], v[118:119], v[88:89], v[136:137]
    v_pk_mul_f32 v[136:137], v[136:137], v[134:135]
    v_lshlrev_b32 v120, 16, v216
    v_and_b32 v121, 0xffff0000, v216
    v_lshlrev_b32 v134, 16, v232
    v_and_b32 v135, 0xffff0000, v232
    v_pk_mul_f32 v[138:139], v[114:115], v[94:95]
    v_pk_fma_f32 v[138:139], v[116:117], v[92:93], v[138:139]
    v_pk_fma_f32 v[138:139], v[118:119], v[90:91], v[138:139]
    v_pk_fma_f32 v[138:139], v[120:121], v[88:89], v[138:139]
    v_pk_mul_f32 v[138:139], v[138:139], v[134:135]
    v_cvt_pk_bf16_f32 v23, v138, v136
    v_cvt_pk_bf16_f32 v31, v139, v137
LP5:
    s_cbranch_execz LPR
    v_lshlrev_b32 v122, 16, v217
    v_and_b32 v123, 0xffff0000, v217
    v_lshlrev_b32 v134, 16, v233
    v_and_b32 v135, 0xffff0000, v233
    v_pk_mul_f32 v[136:137], v[116:117], v[94:95]
    v_pk_fma_f32 v[136:137], v[118:119], v[92:93], v[136:137]
    v_pk_fma_f32 v[136:137], v[120:121], v[90:91], v[136:137]
    v_pk_fma_f32 v[136:137], v[122:123], v[88:89], v[136:137]
    v_pk_mul_f32 v[136:137], v[136:137], v[134:135]
    v_lshlrev_b32 v124, 16, v218
    v_and_b32 v125, 0xffff0000, v218
    v_lshlrev_b32 v134, 16, v234
    v_and_b32 v135, 0xffff0000, v234
    v_pk_mul_f32 v[138:139], v[118:119], v[94:95]
    v_pk_fma_f32 v[138:139], v[120:121], v[92:93], v[138:139]
    v_pk_fma_f32 v[138:139], v[122:123], v[90:91], v[138:139]
    v_pk_fma_f32 v[138:139], v[124:125], v[88:89], v[138:139]
    v_pk_mul_f32 v[138:139], v[138:139], v[134:135]
    v_cvt_pk_bf16_f32 v22, v138, v136
    v_cvt_pk_bf16_f32 v30, v139, v137
    s_waitcnt vmcnt(10)
    v_lshlrev_b32 v126, 16, v219
    v_and_b32 v127, 0xffff0000, v219
    v_lshlrev_b32 v134, 16, v235
    v_and_b32 v135, 0xffff0000, v235
    v_pk_mul_f32 v[136:137], v[120:121], v[94:95]
    v_pk_fma_f32 v[136:137], v[122:123], v[92:93], v[136:137]
    v_pk_fma_f32 v[136:137], v[124:125], v[90:91], v[136:137]
    v_pk_fma_f32 v[136:137], v[126:127], v[88:89], v[136:137]
    v_pk_mul_f32 v[136:137], v[136:137], v[134:135]
    v_lshlrev_b32 v128, 16, v220
    v_and_b32 v129, 0xffff0000, v220
    v_lshlrev_b32 v134, 16, v236
    v_and_b32 v135, 0xffff0000, v236
    v_pk_mul_f32 v[138:139], v[122:123], v[94:95]
    v_pk_fma_f32 v[138:139], v[124:125], v[92:93], v[138:139]
    v_pk_fma_f32 v[138:139], v[126:127], v[90:91], v[138:139]
    v_pk_fma_f32 v[138:139], v[128:129], v[88:89], v[138:139]
    v_pk_mul_f32 v[138:139], v[138:139], v[134:135]
    v_cvt_pk_bf16_f32 v21, v138, v136
    v_cvt_pk_bf16_f32 v29, v139, v137
    v_lshlrev_b32 v130, 16, v221
    v_and_b32 v131, 0xffff0000, v221
    v_lshlrev_b32 v134, 16, v237
    v_and_b32 v135, 0xffff0000, v237
    v_pk_mul_f32 v[136:137], v[124:125], v[94:95]
    v_pk_fma_f32 v[136:137], v[126:127], v[92:93], v[136:137]
    v_pk_fma_f32 v[136:137], v[128:129], v[90:91], v[136:137]
    v_pk_fma_f32 v[136:137], v[130:131], v[88:89], v[136:137]
    v_pk_mul_f32 v[136:137], v[136:137], v[134:135]
    v_lshlrev_b32 v132, 16, v222
    v_and_b32 v133, 0xffff0000, v222
    v_lshlrev_b32 v134, 16, v238
    v_and_b32 v135, 0xffff0000, v238
    v_pk_mul_f32 v[138:139], v[126:127], v[94:95]
    v_pk_fma_f32 v[138:139], v[128:129], v[92:93], v[138:139]
    v_pk_fma_f32 v[138:139], v[130:131], v[90:91], v[138:139]
    v_pk_fma_f32 v[138:139], v[132:133], v[88:89], v[138:139]
    v_pk_mul_f32 v[138:139], v[138:139], v[134:135]
    v_cvt_pk_bf16_f32 v20, v138, v136
    v_cvt_pk_bf16_f32 v28, v139, v137
    v_mul_u32_u24 v10, 272, v1
    s_lshl_b32 s72, s58, 5
    s_add_u32 s72, s72, 84992
    v_add_u32 v10, s72, v10
    ds_write_b128 v10, v[16:19] offset:0
    ds_write_b128 v10, v[20:23] offset:16
    ds_write_b128 v10, v[24:27] offset:128
    ds_write_b128 v10, v[28:31] offset:144
    v_lshrrev_b32 v4, 4, v0
    v_mul_u32_u24 v4, 272, v4
LP6:
    s_cbranch_execz LPR
    v_and_b32 v5, 15, v0
    v_lshl_add_u32 v9, v5, 4, v4
    v_add_u32 v9, 84992, v9
    v_lshrrev_b32 v4, 3, v0
    v_lshlrev_b32 v4, 12, v4
    v_and_b32 v5, 7, v0
    v_lshl_add_u32 v4, v5, 4, v4
    s_lshl_b32 s72, s56, 19
    s_lshl_b32 s73, s57, 7
    s_add_u32 s72, s72, s73
    v_add_u32 v8, s72, v4
    s_mov_b32 s96, 0x20000
    s_mov_b32 s97, 0x40000
    s_mov_b32 s98, 0x60000
    s_waitcnt lgkmcnt(0)
    s_barrier
    s_and_b32 s78, s57, 3
    s_lshl_b32 s78, s78, 2
    s_add_u32 s78, s78, s58
    s_lshl_b32 s99, s78, 6
    v_and_b32 v13, 48, v1
    v_add_u32 v13, s99, v13
    v_mul_u32_u24 v13, 7168, v13
    s_mul_i32 s78, s56, 896
    s_lshr_b32 s75, s57, 2
    s_lshl_b32 s75, s75, 7
    s_add_u32 s78, s78, s75
    v_and_b32 v4, 7, v1
    v_lshl_add_u32 v4, v4, 4, s78
    v_add_u32 v4, v13, v4
    s_cmp_ge_u32 s57, 28
    s_cselect_b32 s86, 0, 7168
    s_cselect_b32 s78, 0, -1
    s_mov_b32 s87, 0
    v_and_b32 v252, s78, v4
    v_mov_b32 v253, 0
    v_and_b32 v6, 8, v1
    v_cmp_eq_u32 vcc, 0, v6
    v_mov_b32 v250, s36
    v_mov_b32 v251, s37
    v_mov_b32 v248, s32
    v_mov_b32 v249, s33
    v_cndmask_b32 v250, v250, v248, vcc
    v_cndmask_b32 v251, v251, v249, vcc
    v_lshl_add_u64 v[250:251], v[252:253], 0, v[250:251]
    ds_read_b128 v[96:99], v9 offset:0
    ds_read_b128 v[100:103], v9 offset:4352
    ds_read_b128 v[104:107], v9 offset:8704
    ds_read_b128 v[108:111], v9 offset:13056
    s_waitcnt lgkmcnt(3)
    buffer_store_dwordx4 v[96:99], v8, s[48:51], 0 offen
    s_waitcnt lgkmcnt(2)
    buffer_store_dwordx4 v[100:103], v8, s[48:51], s96 offen
    s_waitcnt lgkmcnt(1)
    buffer_store_dwordx4 v[104:107], v8, s[48:51], s97 offen
    s_waitcnt lgkmcnt(0)
    buffer_store_dwordx4 v[108:111], v8, s[48:51], s98 offen
    global_load_dwordx4 v[48:51], v[250:251], off nt
    v_lshl_add_u64 v[250:251], v[250:251], 0, s[86:87]
    global_load_dwordx4 v[52:55], v[250:251], off nt
    v_lshl_add_u64 v[250:251], v[250:251], 0, s[86:87]
    global_load_dwordx4 v[56:59], v[250:251], off nt
    v_lshl_add_u64 v[250:251], v[250:251], 0, s[86:87]
    global_load_dwordx4 v[60:63], v[250:251], off nt
    v_lshl_add_u64 v[250:251], v[250:251], 0, s[86:87]
    s_mul_i32 s73, s58, 16640
    v_lshl_add_u32 v33, v1, 4, s73
    s_xor_b32 s100, s59, s61
    s_mov_b32 s101, s100
    s_lshl_b32 s72, s56, 11
    s_add_u32 s72, s72, 4259840
    s_lshl_b32 s3, s58, 5
    s_add_u32 s3, s3, s72
    s_lshl_b32 s73, s57, 2
    s_add_u32 s72, s72, s73
    v_lshrrev_b32 v7, 2, v1
    v_lshl_add_u32 v7, v7, 7, s72
    v_mov_b32 v5, s100
    v_lshlrev_b32 v32, 4, v0
    v_add_u32 v45, 4194304, v32
    s_waitcnt vmcnt(16)
    v_alignbit_b32 v204, v182, v181, 16
    v_mov_b32 v208, v181
    v_alignbit_b32 v212, v181, v180, 16
    v_alignbit_b32 v205, v183, v182, 16
    v_mov_b32 v209, v182
    v_alignbit_b32 v213, v182, v181, 16
    v_alignbit_b32 v206, v184, v183, 16
    v_mov_b32 v210, v183
    v_alignbit_b32 v214, v183, v182, 16
LP7:
    s_cbranch_execz LPR
    v_alignbit_b32 v207, v185, v184, 16
    v_mov_b32 v211, v184
    v_alignbit_b32 v215, v184, v183, 16
    ds_write_b128 v33, v[182:185] offset:32
    ds_write_b128 v33, v[204:207] offset:4192
    ds_write_b128 v33, v[208:211] offset:8352
    ds_write_b128 v33, v[212:215] offset:12512
    s_waitcnt vmcnt(14)
    v_alignbit_b32 v216, v188, v187, 16
    v_mov_b32 v220, v187
    v_alignbit_b32 v224, v187, v186, 16
    v_alignbit_b32 v217, v189, v188, 16
    v_mov_b32 v221, v188
    v_alignbit_b32 v225, v188, v187, 16
    v_alignbit_b32 v218, v190, v189, 16
    v_mov_b32 v222, v189
    v_alignbit_b32 v226, v189, v188, 16
    v_alignbit_b32 v219, v191, v190, 16
    v_mov_b32 v223, v190
    v_alignbit_b32 v227, v190, v189, 16
    ds_write_b128 v33, v[188:191] offset:1056
    ds_write_b128 v33, v[216:219] offset:5216
    ds_write_b128 v33, v[220:223] offset:9376
    ds_write_b128 v33, v[224:227] offset:13536
    s_waitcnt vmcnt(4)
    s_barrier
    s_mov_b64 exec, s[0:1]
    buffer_store_dword v5, v7, s[48:51], 0 offen
    s_mov_b64 exec, -1
    global_load_dwordx4 v[64:67], v[250:251], off nt
    v_lshl_add_u64 v[250:251], v[250:251], 0, s[86:87]
    global_load_dwordx4 v[68:71], v[250:251], off nt
    v_lshl_add_u64 v[250:251], v[250:251], 0, s[86:87]
    global_load_dwordx4 v[72:75], v[250:251], off nt
    v_lshl_add_u64 v[250:251], v[250:251], 0, s[86:87]
    global_load_dwordx4 v[76:79], v[250:251], off nt
    v_lshl_add_u64 v[250:251], v[250:251], 0, s[86:87]
    v_alignbit_b32 v204, v194, v193, 16
    v_mov_b32 v208, v193
    v_alignbit_b32 v212, v193, v192, 16
    v_alignbit_b32 v205, v195, v194, 16
    v_mov_b32 v209, v194
    v_alignbit_b32 v213, v194, v193, 16
    v_alignbit_b32 v206, v196, v195, 16
    v_mov_b32 v210, v195
    v_alignbit_b32 v214, v195, v194, 16
    v_alignbit_b32 v207, v197, v196, 16
    v_mov_b32 v211, v196
    v_alignbit_b32 v215, v196, v195, 16
    ds_write_b128 v33, v[194:197] offset:2080
    ds_write_b128 v33, v[204:207] offset:6240
    ds_write_b128 v33, v[208:211] offset:10400
    ds_write_b128 v33, v[212:215] offset:14560
    v_alignbit_b32 v216, v200, v199, 16
    v_mov_b32 v220, v199
    v_alignbit_b32 v224, v199, v198, 16
    v_alignbit_b32 v217, v201, v200, 16
    v_mov_b32 v221, v200
    v_alignbit_b32 v225, v200, v199, 16
    v_alignbit_b32 v218, v202, v201, 16
    v_mov_b32 v222, v201
    v_alignbit_b32 v226, v201, v200, 16
    v_alignbit_b32 v219, v203, v202, 16
    v_mov_b32 v223, v202
    v_alignbit_b32 v227, v202, v201, 16
    ds_write_b128 v33, v[200:203] offset:3104
    ds_write_b128 v33, v[216:219] offset:7264
    ds_write_b128 v33, v[220:223] offset:11424
    ds_write_b128 v33, v[224:227] offset:15584
    s_mul_i32 s73, s58, 16640
    v_and_b32 v5, 15, v1
    v_sub_u32 v6, 3, v5
    v_and_b32 v6, 3, v6
    v_add3_u32 v5, v5, v6, 1
LP8:
    s_cbranch_execz LPR
    v_mul_u32_u24 v6, 4160, v6
    v_lshl_add_u32 v6, v5, 1, v6
    v_and_b32 v5, 48, v1
    v_add3_u32 v46, v5, v6, s73
    v_and_b32 v4, 15, v1
    v_sub_u32 v4, 15, v4
    v_lshlrev_b32 v5, 4, v4
    v_lshlrev_b32 v5, v5, v11
    v_lshrrev_b32 v6, 4, v1
    v_lshrrev_b32 v4, 1, v4
    v_lshlrev_b32 v6, 2, v6
    v_sub_u32 v4, v4, v6
    v_cmp_eq_u32 vcc, 0, v4
    s_nop 1
    v_cndmask_b32 v244, 0, v5, vcc
    v_cmp_eq_u32 vcc, 1, v4
    s_nop 1
    v_cndmask_b32 v245, 0, v5, vcc
    v_cmp_eq_u32 vcc, 2, v4
    s_nop 1
    v_cndmask_b32 v246, 0, v5, vcc
    v_cmp_eq_u32 vcc, 3, v4
    s_nop 1
    v_cndmask_b32 v247, 0, v5, vcc
    v_mov_b32 v11, v46
    ds_read_b64 a[0:1], v11 offset:0
    ds_read_b64 a[2:3], v11 offset:8
    ds_read_b64 a[32:33], v11 offset:512
    ds_read_b64 a[34:35], v11 offset:520
    ds_read_b64 a[64:65], v11 offset:1024
    ds_read_b64 a[66:67], v11 offset:1032
    ds_read_b64 a[96:97], v11 offset:1536
    ds_read_b64 a[98:99], v11 offset:1544
    ds_read_b64 a[128:129], v11 offset:2048
    ds_read_b64 a[130:131], v11 offset:2056
    ds_read_b64 a[160:161], v11 offset:2560
    ds_read_b64 a[162:163], v11 offset:2568
    ds_read_b64 a[192:193], v11 offset:3072
    ds_read_b64 a[194:195], v11 offset:3080
    ds_read_b64 a[224:225], v11 offset:3584
    ds_read_b64 a[226:227], v11 offset:3592
    ds_read_b64 a[4:5], v11 offset:64
    ds_read_b64 a[6:7], v11 offset:72
    ds_read_b64 a[36:37], v11 offset:576
    ds_read_b64 a[38:39], v11 offset:584
    ds_read_b64 a[68:69], v11 offset:1088
    ds_read_b64 a[70:71], v11 offset:1096
    ds_read_b64 a[100:101], v11 offset:1600
    ds_read_b64 a[102:103], v11 offset:1608
    ds_read_b64 a[132:133], v11 offset:2112
    ds_read_b64 a[134:135], v11 offset:2120
    ds_read_b64 a[164:165], v11 offset:2624
    ds_read_b64 a[166:167], v11 offset:2632
    ds_read_b64 a[196:197], v11 offset:3136
    ds_read_b64 a[198:199], v11 offset:3144
    ds_read_b64 a[228:229], v11 offset:3648
    ds_read_b64 a[230:231], v11 offset:3656
    ds_read_b64 a[8:9], v11 offset:128
    ds_read_b64 a[10:11], v11 offset:136
    ds_read_b64 a[40:41], v11 offset:640
    ds_read_b64 a[42:43], v11 offset:648
    ds_read_b64 a[72:73], v11 offset:1152
    ds_read_b64 a[74:75], v11 offset:1160
    ds_read_b64 a[104:105], v11 offset:1664
    ds_read_b64 a[106:107], v11 offset:1672
    ds_read_b64 a[136:137], v11 offset:2176
    ds_read_b64 a[138:139], v11 offset:2184
    ds_read_b64 a[168:169], v11 offset:2688
    ds_read_b64 a[170:171], v11 offset:2696
    ds_read_b64 a[200:201], v11 offset:3200
    ds_read_b64 a[202:203], v11 offset:3208
    ds_read_b64 a[232:233], v11 offset:3712
    ds_read_b64 a[234:235], v11 offset:3720
    ds_read_b64 a[12:13], v11 offset:192
LP9:
    s_cbranch_execz LPR
    ds_read_b64 a[14:15], v11 offset:200
    ds_read_b64 a[44:45], v11 offset:704
    ds_read_b64 a[46:47], v11 offset:712
    ds_read_b64 a[76:77], v11 offset:1216
    ds_read_b64 a[78:79], v11 offset:1224
    ds_read_b64 a[108:109], v11 offset:1728
    ds_read_b64 a[110:111], v11 offset:1736
    ds_read_b64 a[140:141], v11 offset:2240
    ds_read_b64 a[142:143], v11 offset:2248
    ds_read_b64 a[172:173], v11 offset:2752
    ds_read_b64 a[174:175], v11 offset:2760
    ds_read_b64 a[204:205], v11 offset:3264
    ds_read_b64 a[206:207], v11 offset:3272
    ds_read_b64 a[236:237], v11 offset:3776
    ds_read_b64 a[238:239], v11 offset:3784
    s_mul_i32 s72, s58, 4608
    s_add_u32 s73, s72, 67040
    s_mov_b32 m0, s73
    v_and_b32 v4, 15, v1
    v_lshlrev_b32 v4, 5, v4
    v_and_b32 v5, 48, v1
    v_sub_u32 v4, v4, v5
    s_add_u32 s72, s72, 66608
    v_add_u32 v13, s72, v4
    v_mov_b32 v4, 140320
    s_add_u32 s78, s3, 0
    s_mov_b32 s62, 15
LB5:
    s_load_dwordx8 s[88:95], s[48:49], s78
    s_waitcnt lgkmcnt(0)
    s_cmp_eq_u64 s[88:89], s[100:101]
    s_cbranch_scc0 LB6
    s_cmp_eq_u64 s[90:91], s[100:101]
    s_cbranch_scc0 LB6
    s_cmp_eq_u64 s[92:93], s[100:101]
    s_cbranch_scc0 LB6
    s_cmp_eq_u64 s[94:95], s[100:101]
    s_cbranch_scc1 LB7
LB6:
    s_add_u32 s78, s78, 128
    s_sub_u32 s62, s62, 1
    s_cbranch_scc0 LB5
    ds_write_b32 v4, v14
    s_waitcnt lgkmcnt(0)
LB7:
    s_barrier
    ds_read_b32 v228, v4
    buffer_load_dwordx4 v12, s[48:51], 0 offen offset:0 nt lds
    buffer_load_dwordx4 v12, s[48:51], 0 offen offset:1024 nt lds
    buffer_load_dwordx4 v12, s[48:51], 0 offen offset:2048 nt lds
    buffer_load_dwordx4 v12, s[48:51], 0 offen offset:3072 nt lds
    s_waitcnt lgkmcnt(0)
    v_cmp_ne_u32 vcc, 0, v228
    s_cbranch_vccnz LSLOW
LJOIN:
    buffer_load_dwordx4 v[16:19], v45, s[48:51], 0 offen nt
    buffer_load_dwordx4 v[20:23], v45, s[48:51], s65 offen nt
    buffer_load_dwordx4 v[24:27], v45, s[48:51], s66 offen nt
    buffer_load_dwordx4 v[28:31], v45, s[48:51], s67 offen nt
    global_load_dwordx4 v[80:83], v[250:251], off nt
    v_lshl_add_u64 v[250:251], v[250:251], 0, s[86:87]
    ds_read_b64 a[16:17], v11 offset:256
    ds_read_b64 a[18:19], v11 offset:264
    ds_read_b64 a[48:49], v11 offset:768
    ds_read_b64 a[50:51], v11 offset:776
    ds_read_b64 a[80:81], v11 offset:1280
    ds_read_b64 a[82:83], v11 offset:1288
    ds_read_b64 a[112:113], v11 offset:1792
    ds_read_b64 a[114:115], v11 offset:1800
    ds_read_b64 a[144:145], v11 offset:2304
    ds_read_b64 a[146:147], v11 offset:2312
    ds_read_b64 a[176:177], v11 offset:2816
    ds_read_b64 a[178:179], v11 offset:2824
    ds_read_b64 a[208:209], v11 offset:3328
    ds_read_b64 a[210:211], v11 offset:3336
    ds_read_b64 a[240:241], v11 offset:3840
    ds_read_b64 a[242:243], v11 offset:3848
    global_load_dwordx4 v[84:87], v[250:251], off nt
    v_lshl_add_u64 v[250:251], v[250:251], 0, s[86:87]
    ds_read_b64 a[20:21], v11 offset:320
LP10:
    s_cbranch_execz LPR
    ds_read_b64 a[22:23], v11 offset:328
    ds_read_b64 a[52:53], v11 offset:832
    ds_read_b64 a[54:55], v11 offset:840
    ds_read_b64 a[84:85], v11 offset:1344
    ds_read_b64 a[86:87], v11 offset:1352
    ds_read_b64 a[116:117], v11 offset:1856
    ds_read_b64 a[118:119], v11 offset:1864
    ds_read_b64 a[148:149], v11 offset:2368
    ds_read_b64 a[150:151], v11 offset:2376
    ds_read_b64 a[180:181], v11 offset:2880
    ds_read_b64 a[182:183], v11 offset:2888
    ds_read_b64 a[212:213], v11 offset:3392
    ds_read_b64 a[214:215], v11 offset:3400
    ds_read_b64 a[244:245], v11 offset:3904
    ds_read_b64 a[246:247], v11 offset:3912
    global_load_dwordx4 v[88:91], v[250:251], off nt
    v_lshl_add_u64 v[250:251], v[250:251], 0, s[86:87]
    ds_read_b64 a[24:25], v11 offset:384
    ds_read_b64 a[26:27], v11 offset:392
    ds_read_b64 a[56:57], v11 offset:896
    ds_read_b64 a[58:59], v11 offset:904
    ds_read_b64 a[88:89], v11 offset:1408
    ds_read_b64 a[90:91], v11 offset:1416
    ds_read_b64 a[120:121], v11 offset:1920
    ds_read_b64 a[122:123], v11 offset:1928
    ds_read_b64 a[152:153], v11 offset:2432
    ds_read_b64 a[154:155], v11 offset:2440
    ds_read_b64 a[184:185], v11 offset:2944
    ds_read_b64 a[186:187], v11 offset:2952
    ds_read_b64 a[216:217], v11 offset:3456
    ds_read_b64 a[218:219], v11 offset:3464
    ds_read_b64 a[248:249], v11 offset:3968
    ds_read_b64 a[250:251], v11 offset:3976
    global_load_dwordx4 v[92:95], v[250:251], off nt
    v_lshl_add_u64 v[250:251], v[250:251], 0, s[86:87]
    ds_read_b64 a[28:29], v11 offset:448
    ds_read_b64 a[30:31], v11 offset:456
    ds_read_b64 a[60:61], v11 offset:960
    ds_read_b64 a[62:63], v11 offset:968
    ds_read_b64 a[92:93], v11 offset:1472
    ds_read_b64 a[94:95], v11 offset:1480
    ds_read_b64 a[124:125], v11 offset:1984
    ds_read_b64 a[126:127], v11 offset:1992
    ds_read_b64 a[156:157], v11 offset:2496
    ds_read_b64 a[158:159], v11 offset:2504
    ds_read_b64 a[188:189], v11 offset:3008
    ds_read_b64 a[190:191], v11 offset:3016
    ds_read_b64 a[220:221], v11 offset:3520
    ds_read_b64 a[222:223], v11 offset:3528
    ds_read_b64 a[252:253], v11 offset:4032
    ds_read_b64 a[254:255], v11 offset:4040
    s_waitcnt vmcnt(8)
    ds_read_b128 v[180:183], v13 offset:448
    ds_read_b128 v[184:187], v13 offset:960
    ds_read_b128 v[188:191], v13 offset:1472
    ds_read_b128 v[192:195], v13 offset:1984
    ds_read_b128 v[196:199], v13 offset:2496
    ds_read_b128 v[200:203], v13 offset:3008
    ds_read_b128 v[204:207], v13 offset:3520
    ds_read_b128 v[208:211], v13 offset:4032
    s_waitcnt lgkmcnt(7)
    v_mfma_f32_16x16x32_bf16 v[148:151], v[244:247], v[180:183], 0
    s_waitcnt lgkmcnt(6)
    v_mfma_f32_16x16x32_bf16 v[152:155], v[244:247], v[184:187], 0
    s_waitcnt lgkmcnt(5)
LP11:
    s_cbranch_execz LPR
    v_mfma_f32_16x16x32_bf16 v[156:159], v[244:247], v[188:191], 0
    s_waitcnt lgkmcnt(4)
    v_mfma_f32_16x16x32_bf16 v[160:163], v[244:247], v[192:195], 0
    s_waitcnt lgkmcnt(3)
    v_mfma_f32_16x16x32_bf16 v[164:167], v[244:247], v[196:199], 0
    s_waitcnt lgkmcnt(2)
    v_mfma_f32_16x16x32_bf16 v[168:171], v[244:247], v[200:203], 0
    s_waitcnt lgkmcnt(1)
    v_mfma_f32_16x16x32_bf16 v[172:175], v[244:247], v[204:207], 0
    s_waitcnt lgkmcnt(0)
    v_mfma_f32_16x16x32_bf16 v[176:179], v[244:247], v[208:211], 0
    s_waitcnt lgkmcnt(0)
    v_mfma_f32_16x16x32_bf16 v[148:151], a[0:3], v[180:183], v[148:151]
    ds_read_b128 v[212:215], v13 offset:384
    s_mul_i32 s78, s56, 448
    v_mfma_f32_16x16x32_bf16 v[152:155], a[32:35], v[180:183], v[152:155]
    ds_read_b128 v[216:219], v13 offset:896
    s_lshr_b32 s79, s57, 3
    v_mfma_f32_16x16x32_bf16 v[156:159], a[64:67], v[180:183], v[156:159]
    ds_read_b128 v[220:223], v13 offset:1408
    s_mul_i32 s79, s79, 112
    v_mfma_f32_16x16x32_bf16 v[160:163], a[96:99], v[180:183], v[160:163]
    ds_read_b128 v[224:227], v13 offset:1920
    s_add_u32 s78, s78, s79
    v_mfma_f32_16x16x32_bf16 v[164:167], a[128:131], v[180:183], v[164:167]
    ds_read_b128 v[228:231], v13 offset:2432
    s_mul_i32 s63, s58, 28
    v_mfma_f32_16x16x32_bf16 v[168:171], a[160:163], v[180:183], v[168:171]
    ds_read_b128 v[232:235], v13 offset:2944
    s_add_u32 s78, s78, s63
    v_mfma_f32_16x16x32_bf16 v[172:175], a[192:195], v[180:183], v[172:175]
    ds_read_b128 v[236:239], v13 offset:3456
    s_add_u32 s63, s63, s79
    v_mfma_f32_16x16x32_bf16 v[176:179], a[224:227], v[180:183], v[176:179]
    ds_read_b128 v[240:243], v13 offset:3968
    v_lshrrev_b32 v4, 4, v1
    v_mfma_f32_16x16x32_bf16 v[152:155], a[0:3], v[184:187], v[152:155]
    v_mul_u32_u24 v4, 7, v4
    v_add_u32 v4, s78, v4
    v_mfma_f32_16x16x32_bf16 v[156:159], a[32:35], v[184:187], v[156:159]
    v_lshlrev_b32 v4, 11, v4
    s_and_b32 s78, s57, 7
    v_mfma_f32_16x16x32_bf16 v[160:163], a[64:67], v[184:187], v[160:163]
    s_lshl_b32 s78, s78, 8
    v_and_b32 v5, 15, v1
    v_mfma_f32_16x16x32_bf16 v[164:167], a[96:99], v[184:187], v[164:167]
    v_lshl_add_u32 v5, v5, 4, s78
    v_add_u32 v46, v4, v5
    v_mfma_f32_16x16x32_bf16 v[168:171], a[128:131], v[184:187], v[168:171]
    v_add_u32 v6, 119808, v32
    v_lshlrev_b32 v4, 1, v0
    v_mfma_f32_16x16x32_bf16 v[172:175], a[160:163], v[184:187], v[172:175]
    v_mov_b32 v44, 0xffff
    v_sub_u32 v34, 2047, v4
    v_mfma_f32_16x16x32_bf16 v[176:179], a[192:195], v[184:187], v[176:179]
    v_sub_u32 v35, 2046, v4
    v_sub_u32 v36, 1535, v4
    v_mfma_f32_16x16x32_bf16 v[156:159], a[0:3], v[188:191], v[156:159]
    v_sub_u32 v37, 1534, v4
    v_sub_u32 v38, 1023, v4
    v_mfma_f32_16x16x32_bf16 v[160:163], a[32:35], v[188:191], v[160:163]
    v_sub_u32 v39, 1022, v4
    v_sub_u32 v40, 511, v4
    v_mfma_f32_16x16x32_bf16 v[164:167], a[64:67], v[188:191], v[164:167]
    v_sub_u32 v41, 510, v4
    v_and_b32 v4, 1, v1
    v_mfma_f32_16x16x32_bf16 v[168:171], a[96:99], v[188:191], v[168:171]
    v_lshlrev_b32 v4, 4, v4
    v_lshlrev_b32 v4, v4, v44
    v_mfma_f32_16x16x32_bf16 v[172:175], a[128:131], v[188:191], v[172:175]
    v_bfe_u32 v5, v1, 1, 2
    v_cmp_eq_u32 vcc, 0, v5
    v_mfma_f32_16x16x32_bf16 v[176:179], a[160:163], v[188:191], v[176:179]
    global_load_dwordx4 v[96:99], v[250:251], off nt
    v_lshl_add_u64 v[250:251], v[250:251], 0, s[86:87]
    v_mfma_f32_16x16x32_bf16 v[160:163], a[0:3], v[192:195], v[160:163]
LP12:
    s_cbranch_execz LPR
    v_cndmask_b32 v244, 0, v4, vcc
    v_cmp_eq_u32 vcc, 1, v5
    v_mfma_f32_16x16x32_bf16 v[164:167], a[32:35], v[192:195], v[164:167]
    v_mfma_f32_16x16x32_bf16 v[168:171], a[64:67], v[192:195], v[168:171]
    v_cndmask_b32 v245, 0, v4, vcc
    v_cmp_eq_u32 vcc, 2, v5
    v_mfma_f32_16x16x32_bf16 v[172:175], a[96:99], v[192:195], v[172:175]
    v_mfma_f32_16x16x32_bf16 v[176:179], a[128:131], v[192:195], v[176:179]
    v_cndmask_b32 v246, 0, v4, vcc
    v_cmp_eq_u32 vcc, 3, v5
    v_mfma_f32_16x16x32_bf16 v[164:167], a[0:3], v[196:199], v[164:167]
    v_mfma_f32_16x16x32_bf16 v[168:171], a[32:35], v[196:199], v[168:171]
    v_cndmask_b32 v247, 0, v4, vcc
    s_lshl_b32 s73, s58, 3
    v_mfma_f32_16x16x32_bf16 v[172:175], a[64:67], v[196:199], v[172:175]
    s_add_u32 s73, s73, 140288
    v_mov_b32 v47, s73
    v_mfma_f32_16x16x32_bf16 v[176:179], a[96:99], v[196:199], v[176:179]
    s_lshl_b32 s78, s58, 10
    s_add_u32 s78, s78, 136192
    v_mfma_f32_16x16x32_bf16 v[168:171], a[0:3], v[200:203], v[168:171]
    v_lshl_add_u32 v144, v1, 2, s78
    v_and_b32 v4, 8, v1
    v_mfma_f32_16x16x32_bf16 v[172:175], a[32:35], v[200:203], v[172:175]
    v_lshlrev_b32 v4, 3, v4
    v_and_or_b32 v4, v1, 48, v4
    v_mfma_f32_16x16x32_bf16 v[176:179], a[64:67], v[200:203], v[176:179]
    global_load_dwordx4 v[100:103], v[250:251], off nt
    v_lshl_add_u64 v[250:251], v[250:251], 0, s[86:87]
    v_mfma_f32_16x16x32_bf16 v[172:175], a[0:3], v[204:207], v[172:175]
    v_lshl_add_u32 v145, v4, 2, s78
    v_add_u32 v33, s99, v1
    v_mfma_f32_16x16x32_bf16 v[176:179], a[32:35], v[204:207], v[176:179]
    v_lshlrev_b32 v33, 1, v33
    s_mov_b32 s76, 0x0c0c0400
    v_mfma_f32_16x16x32_bf16 v[176:179], a[0:3], v[208:211], v[176:179]
    s_mov_b32 s77, 0x04000c0c
    s_lshr_b32 s72, s59, 0
    s_waitcnt lgkmcnt(0)
    v_mfma_f32_16x16x32_bf16 v[148:151], a[4:7], v[212:215], v[148:151]
    ds_read_b128 v[180:183], v13 offset:320
    s_lshr_b32 s73, s59, 8
    v_mfma_f32_16x16x32_bf16 v[152:155], a[36:39], v[212:215], v[152:155]
    ds_read_b128 v[184:187], v13 offset:832
    s_lshr_b32 s74, s59, 16
    v_mfma_f32_16x16x32_bf16 v[156:159], a[68:71], v[212:215], v[156:159]
    ds_read_b128 v[188:191], v13 offset:1344
    s_lshr_b32 s75, s59, 24
    v_mfma_f32_16x16x32_bf16 v[160:163], a[100:103], v[212:215], v[160:163]
    ds_read_b128 v[192:195], v13 offset:1856
    v_and_b32 v4, 15, v1
    v_mfma_f32_16x16x32_bf16 v[164:167], a[132:135], v[212:215], v[164:167]
    ds_read_b128 v[196:199], v13 offset:2368
    v_lshlrev_b32 v4, 5, v4
    v_mfma_f32_16x16x32_bf16 v[168:171], a[164:167], v[212:215], v[168:171]
    ds_read_b128 v[200:203], v13 offset:2880
    v_lshrrev_b32 v5, 4, v1
    v_mfma_f32_16x16x32_bf16 v[172:175], a[196:199], v[212:215], v[172:175]
    ds_read_b128 v[204:207], v13 offset:3392
    v_lshl_add_u32 v4, v5, 3, v4
    v_mfma_f32_16x16x32_bf16 v[176:179], a[228:231], v[212:215], v[176:179]
    ds_read_b128 v[208:211], v13 offset:3904
    v_and_b32 v5, 0xfffff000, v12
    v_mfma_f32_16x16x32_bf16 v[152:155], a[4:7], v[216:219], v[152:155]
    v_add_u32 v12, v4, v5
    s_mul_i32 s78, s56, 28672
    v_mfma_f32_16x16x32_bf16 v[156:159], a[36:39], v[216:219], v[156:159]
    global_load_dwordx4 v[104:107], v[250:251], off nt
    v_lshl_add_u64 v[250:251], v[250:251], 0, s[86:87]
    v_mfma_f32_16x16x32_bf16 v[160:163], a[68:71], v[216:219], v[160:163]
    s_lshl_b32 s79, s63, 2
    s_add_u32 s78, s78, s79
    v_mfma_f32_16x16x32_bf16 v[164:167], a[100:103], v[216:219], v[164:167]
    s_add_u32 s78, s78, 4325376
    v_and_b32 v4, 3, v1
    v_mfma_f32_16x16x32_bf16 v[168:171], a[132:135], v[216:219], v[168:171]
LP13:
    s_cbranch_execz LPR
    v_mul_u32_u24 v4, 7168, v4
    v_lshrrev_b32 v5, 5, v1
    v_mfma_f32_16x16x32_bf16 v[172:175], a[164:167], v[216:219], v[172:175]
    v_mul_u32_u24 v5, 1792, v5
    v_add3_u32 v4, v4, v5, s78
    v_mfma_f32_16x16x32_bf16 v[176:179], a[196:199], v[216:219], v[176:179]
    v_bfe_u32 v5, v1, 2, 3
    v_min_u32 v5, 6, v5
    v_mfma_f32_16x16x32_bf16 v[156:159], a[4:7], v[220:223], v[156:159]
    v_lshl_add_u32 v147, v5, 4, v4
    s_and_b32 s78, s57, 7
    v_mfma_f32_16x16x32_bf16 v[160:163], a[36:39], v[220:223], v[160:163]
    s_lshl_b32 s78, s78, 6
    s_lshl_b32 s79, s56, 2
    v_mfma_f32_16x16x32_bf16 v[164:167], a[68:71], v[220:223], v[164:167]
    s_add_u32 s78, s78, s79
    s_lshr_b32 s79, s57, 3
    v_mfma_f32_16x16x32_bf16 v[168:171], a[100:103], v[220:223], v[168:171]
    global_load_dwordx4 v[108:111], v[250:251], off nt
    v_lshl_add_u64 v[250:251], v[250:251], 0, s[86:87]
    v_mfma_f32_16x16x32_bf16 v[172:175], a[132:135], v[220:223], v[172:175]
    s_add_u32 s78, s78, s79
    s_lshl_b32 s78, s78, 9
    v_mfma_f32_16x16x32_bf16 v[176:179], a[164:167], v[220:223], v[176:179]
    s_add_u32 s78, s78, 4587520
    v_lshrrev_b32 v146, 5, v1
    v_mfma_f32_16x16x32_bf16 v[160:163], a[4:7], v[224:227], v[160:163]
    v_lshlrev_b32 v146, 14, v146
    v_and_b32 v5, 15, v1
    v_mfma_f32_16x16x32_bf16 v[164:167], a[36:39], v[224:227], v[164:167]
    v_lshl_add_u32 v146, v5, 5, v146
    v_and_b32 v5, 16, v1
    v_mfma_f32_16x16x32_bf16 v[168:171], a[68:71], v[224:227], v[168:171]
    v_add3_u32 v146, v146, v5, s78
    v_bfe_u32 v4, v1, 3, 1
    v_mfma_f32_16x16x32_bf16 v[172:175], a[100:103], v[224:227], v[172:175]
    v_lshrrev_b32 v5, 4, v1
    v_mul_u32_u24 v5, 28, v5
    v_mfma_f32_16x16x32_bf16 v[176:179], a[132:135], v[224:227], v[176:179]
    v_lshl_add_u32 v2, v4, 7, v5
    buffer_load_dword v140, v7, s[48:51], s68 offen nt
    v_mfma_f32_16x16x32_bf16 v[164:167], a[4:7], v[228:231], v[164:167]
    s_waitcnt vmcnt(9)
    v_xor_b32 v252, s59, v19
    v_xor_b32 v253, s59, v23
    v_mfma_f32_16x16x32_bf16 v[168:171], a[36:39], v[228:231], v[168:171]
    v_xor_b32 v254, s59, v27
    v_xor_b32 v255, s59, v31
    v_mfma_f32_16x16x32_bf16 v[172:175], a[68:71], v[228:231], v[172:175]
    v_or3_b32 v252, v252, v253, v254
    v_or_b32 v252, v252, v255
    v_mfma_f32_16x16x32_bf16 v[176:179], a[100:103], v[228:231], v[176:179]
    v_cmp_ne_u32 vcc, 0, v252
    s_cbranch_vccnz LRETRY
LRBACK:
    v_mfma_f32_16x16x32_bf16 v[168:171], a[4:7], v[232:235], v[168:171]
    v_lshl_or_b32 v34, v18, 16, v34
    v_bfi_b32 v35, v44, v35, v18
    v_mfma_f32_16x16x32_bf16 v[172:175], a[36:39], v[232:235], v[172:175]
    v_lshl_or_b32 v36, v22, 16, v36
    v_bfi_b32 v37, v44, v37, v22
    v_mfma_f32_16x16x32_bf16 v[176:179], a[68:71], v[232:235], v[176:179]
    v_lshl_or_b32 v38, v26, 16, v38
    v_bfi_b32 v39, v44, v39, v26
    v_mfma_f32_16x16x32_bf16 v[172:175], a[4:7], v[236:239], v[172:175]
    v_lshl_or_b32 v40, v30, 16, v40
    v_bfi_b32 v41, v44, v41, v30
    v_mfma_f32_16x16x32_bf16 v[176:179], a[36:39], v[236:239], v[176:179]
    v_max_u32 v42, v34, v35
    v_min_u32 v43, v34, v35
    v_mfma_f32_16x16x32_bf16 v[176:179], a[4:7], v[240:243], v[176:179]
    v_med3_u32 v43, v42, v43, v36
    v_max_u32 v42, v42, v36
    s_waitcnt lgkmcnt(0)
    v_mfma_f32_16x16x32_bf16 v[148:151], a[8:11], v[180:183], v[148:151]
    ds_read_b128 v[212:215], v13 offset:256
    v_med3_u32 v43, v42, v43, v37
    v_mfma_f32_16x16x32_bf16 v[152:155], a[40:43], v[180:183], v[152:155]
LP14:
    s_cbranch_execz LPR
    ds_read_b128 v[216:219], v13 offset:768
    v_max_u32 v42, v42, v37
    v_mfma_f32_16x16x32_bf16 v[156:159], a[72:75], v[180:183], v[156:159]
    ds_read_b128 v[220:223], v13 offset:1280
    v_med3_u32 v43, v42, v43, v38
    v_mfma_f32_16x16x32_bf16 v[160:163], a[104:107], v[180:183], v[160:163]
    ds_read_b128 v[224:227], v13 offset:1792
    v_max_u32 v42, v42, v38
    v_mfma_f32_16x16x32_bf16 v[164:167], a[136:139], v[180:183], v[164:167]
    ds_read_b128 v[228:231], v13 offset:2304
    v_med3_u32 v43, v42, v43, v39
    v_mfma_f32_16x16x32_bf16 v[168:171], a[168:171], v[180:183], v[168:171]
    ds_read_b128 v[232:235], v13 offset:2816
    v_max_u32 v42, v42, v39
    v_mfma_f32_16x16x32_bf16 v[172:175], a[200:203], v[180:183], v[172:175]
    ds_read_b128 v[236:239], v13 offset:3328
    v_med3_u32 v43, v42, v43, v40
    v_mfma_f32_16x16x32_bf16 v[176:179], a[232:235], v[180:183], v[176:179]
    ds_read_b128 v[240:243], v13 offset:3840
    v_max_u32 v42, v42, v40
    v_mfma_f32_16x16x32_bf16 v[152:155], a[8:11], v[184:187], v[152:155]
    v_med3_u32 v43, v42, v43, v41
    v_max_u32 v42, v42, v41
    v_mfma_f32_16x16x32_bf16 v[156:159], a[40:43], v[184:187], v[156:159]
    v_mov_b32 v4, v42
    v_mfma_f32_16x16x32_bf16 v[160:163], a[72:75], v[184:187], v[160:163]
    v_mfma_f32_16x16x32_bf16 v[164:167], a[104:107], v[184:187], v[164:167]
    v_max_u32_dpp v4, v4, v4 quad_perm:[1,0,3,2] row_mask:0xf bank_mask:0xf
    ds_write_b128 v6, v[16:19] offset:0
    v_mfma_f32_16x16x32_bf16 v[168:171], a[136:139], v[184:187], v[168:171]
    v_max_u32_dpp v4, v4, v4 quad_perm:[2,3,0,1] row_mask:0xf bank_mask:0xf
    ds_write_b128 v6, v[20:23] offset:4096
    v_mfma_f32_16x16x32_bf16 v[172:175], a[168:171], v[184:187], v[172:175]
    v_max_u32_dpp v4, v4, v4 row_half_mirror row_mask:0xf bank_mask:0xf
    ds_write_b128 v6, v[24:27] offset:8192
    v_mfma_f32_16x16x32_bf16 v[176:179], a[200:203], v[184:187], v[176:179]
    v_max_u32_dpp v4, v4, v4 row_mirror row_mask:0xf bank_mask:0xf
    ds_write_b128 v6, v[28:31] offset:12288
    v_mfma_f32_16x16x32_bf16 v[156:159], a[8:11], v[188:191], v[156:159]
    v_max_u32_dpp v4, v4, v4 row_bcast:15 row_mask:0xa bank_mask:0xf
    v_mfma_f32_16x16x32_bf16 v[160:163], a[40:43], v[188:191], v[160:163]
    v_mfma_f32_16x16x32_bf16 v[164:167], a[72:75], v[188:191], v[164:167]
    v_max_u32_dpp v4, v4, v4 row_bcast:31 row_mask:0xc bank_mask:0xf
    v_mfma_f32_16x16x32_bf16 v[168:171], a[104:107], v[188:191], v[168:171]
    v_readlane_b32 s78, v4, 63
    v_mfma_f32_16x16x32_bf16 v[172:175], a[136:139], v[188:191], v[172:175]
    v_mfma_f32_16x16x32_bf16 v[176:179], a[168:171], v[188:191], v[176:179]
    v_cmp_eq_u32 vcc, s78, v42
    v_mfma_f32_16x16x32_bf16 v[160:163], a[8:11], v[192:195], v[160:163]
    v_mfma_f32_16x16x32_bf16 v[164:167], a[40:43], v[192:195], v[164:167]
    v_cndmask_b32 v5, v42, v43, vcc
    v_mfma_f32_16x16x32_bf16 v[168:171], a[72:75], v[192:195], v[168:171]
    v_mfma_f32_16x16x32_bf16 v[172:175], a[104:107], v[192:195], v[172:175]
    v_max_u32_dpp v5, v5, v5 quad_perm:[1,0,3,2] row_mask:0xf bank_mask:0xf
    v_mfma_f32_16x16x32_bf16 v[176:179], a[136:139], v[192:195], v[176:179]
    v_mfma_f32_16x16x32_bf16 v[164:167], a[8:11], v[196:199], v[164:167]
    v_max_u32_dpp v5, v5, v5 quad_perm:[2,3,0,1] row_mask:0xf bank_mask:0xf
    v_mfma_f32_16x16x32_bf16 v[168:171], a[40:43], v[196:199], v[168:171]
    v_mfma_f32_16x16x32_bf16 v[172:175], a[72:75], v[196:199], v[172:175]
    v_max_u32_dpp v5, v5, v5 row_half_mirror row_mask:0xf bank_mask:0xf
    v_mfma_f32_16x16x32_bf16 v[176:179], a[104:107], v[196:199], v[176:179]
    v_mfma_f32_16x16x32_bf16 v[168:171], a[8:11], v[200:203], v[168:171]
    v_max_u32_dpp v5, v5, v5 row_mirror row_mask:0xf bank_mask:0xf
    v_mfma_f32_16x16x32_bf16 v[172:175], a[40:43], v[200:203], v[172:175]
    v_mfma_f32_16x16x32_bf16 v[176:179], a[72:75], v[200:203], v[176:179]
    v_max_u32_dpp v5, v5, v5 row_bcast:15 row_mask:0xa bank_mask:0xf
    v_mfma_f32_16x16x32_bf16 v[172:175], a[8:11], v[204:207], v[172:175]
    v_mfma_f32_16x16x32_bf16 v[176:179], a[40:43], v[204:207], v[176:179]
LP15:
    s_cbranch_execz LPR
    v_max_u32_dpp v5, v5, v5 row_bcast:31 row_mask:0xc bank_mask:0xf
    s_mov_b32 exec_lo, 0
    s_mov_b32 exec_hi, 0x80000000
    ds_write_b64 v47, v[4:5]
    s_mov_b64 exec, -1
    v_mfma_f32_16x16x32_bf16 v[176:179], a[8:11], v[208:211], v[176:179]
    v_mov_b32 v4, 140288
    s_waitcnt lgkmcnt(0)
    v_mfma_f32_16x16x32_bf16 v[148:151], a[12:15], v[212:215], v[148:151]
    ds_read_b128 v[180:183], v13 offset:192
    v_mfma_f32_16x16x32_bf16 v[152:155], a[44:47], v[212:215], v[152:155]
    ds_read_b128 v[184:187], v13 offset:704
    s_waitcnt lgkmcnt(0)
    s_barrier
    ds_read_b128 v[34:37], v4
    ds_read_b128 v[38:41], v4 offset:16
    v_mfma_f32_16x16x32_bf16 v[156:159], a[76:79], v[212:215], v[156:159]
    ds_read_b128 v[188:191], v13 offset:1216
    v_mfma_f32_16x16x32_bf16 v[160:163], a[108:111], v[212:215], v[160:163]
    ds_read_b128 v[192:195], v13 offset:1728
    v_mfma_f32_16x16x32_bf16 v[164:167], a[140:143], v[212:215], v[164:167]
    ds_read_b128 v[196:199], v13 offset:2240
    v_mfma_f32_16x16x32_bf16 v[168:171], a[172:175], v[212:215], v[168:171]
    ds_read_b128 v[200:203], v13 offset:2752
    v_mfma_f32_16x16x32_bf16 v[172:175], a[204:207], v[212:215], v[172:175]
    ds_read_b128 v[204:207], v13 offset:3264
    s_waitcnt lgkmcnt(0)
    v_min_u32 v42, v34, v36
    v_mfma_f32_16x16x32_bf16 v[176:179], a[236:239], v[212:215], v[176:179]
    ds_read_b128 v[208:211], v13 offset:3776
    v_max_u32 v34, v34, v36
    v_mfma_f32_16x16x32_bf16 v[152:155], a[12:15], v[216:219], v[152:155]
    v_max3_u32 v35, v42, v35, v37
    v_min_u32 v42, v38, v40
    v_mfma_f32_16x16x32_bf16 v[156:159], a[44:47], v[216:219], v[156:159]
    v_max_u32 v38, v38, v40
    v_max3_u32 v39, v42, v39, v41
    v_mfma_f32_16x16x32_bf16 v[160:163], a[76:79], v[216:219], v[160:163]
    v_min_u32 v42, v34, v38
    v_max_u32 v34, v34, v38
    v_mfma_f32_16x16x32_bf16 v[164:167], a[108:111], v[216:219], v[164:167]
    v_max3_u32 v35, v42, v35, v39
    v_readfirstlane_b32 s88, v34
    v_mfma_f32_16x16x32_bf16 v[168:171], a[140:143], v[216:219], v[168:171]
    v_readfirstlane_b32 s89, v35
    s_andn2_b32 s80, 0x7ff, s88
    v_mfma_f32_16x16x32_bf16 v[172:175], a[172:175], v[216:219], v[172:175]
    s_lshl_b32 s91, s80, 11
    buffer_load_ushort v140, v33, s[4:7], s91 offen
    v_mfma_f32_16x16x32_bf16 v[176:179], a[204:207], v[216:219], v[176:179]
    s_andn2_b32 s81, 0x7ff, s89
    s_lshl_b32 s91, s81, 11
    v_mfma_f32_16x16x32_bf16 v[156:159], a[12:15], v[220:223], v[156:159]
    buffer_load_ushort v141, v33, s[4:7], s91 offen
    s_and_b32 s79, s80, 1
    v_mfma_f32_16x16x32_bf16 v[160:163], a[44:47], v[220:223], v[160:163]
    s_lshl_b32 s78, s80, 1
    s_sub_u32 s78, s78, s79
    v_mfma_f32_16x16x32_bf16 v[164:167], a[76:79], v[220:223], v[164:167]
    s_lshl_b32 s78, s78, 2
    s_bitset1_b32 s78, 16
    v_mfma_f32_16x16x32_bf16 v[168:171], a[108:111], v[220:223], v[168:171]
    v_mov_b32 v4, s78
    buffer_load_dwordx4 v[112:115], v46, s[40:43], 0 offen offset:0 nt
    v_mfma_f32_16x16x32_bf16 v[172:175], a[140:143], v[220:223], v[172:175]
    ds_read_b32 v142, v4 offset:54272
    s_and_b32 s90, s88, 0x7fff0000
    v_mfma_f32_16x16x32_bf16 v[176:179], a[172:175], v[220:223], v[176:179]
    s_andn2_b32 s91, 0xffff0000, s88
    s_bitcmp1_b32 s88, 31
    s_cselect_b32 s82, s90, s91
    v_mfma_f32_16x16x32_bf16 v[160:163], a[12:15], v[224:227], v[160:163]
    s_and_b32 s79, s81, 1
    s_lshl_b32 s78, s81, 1
    v_mfma_f32_16x16x32_bf16 v[164:167], a[44:47], v[224:227], v[164:167]
    buffer_load_dwordx4 v[116:119], v46, s[40:43], 0 offen offset:2048 nt
LP16:
    s_cbranch_execz LPR
    s_sub_u32 s78, s78, s79
    v_mfma_f32_16x16x32_bf16 v[168:171], a[76:79], v[224:227], v[168:171]
    s_lshl_b32 s78, s78, 2
    s_bitset1_b32 s78, 16
    v_mfma_f32_16x16x32_bf16 v[172:175], a[108:111], v[224:227], v[172:175]
    v_mov_b32 v4, s78
    ds_read_b32 v143, v4 offset:54272
    v_mfma_f32_16x16x32_bf16 v[176:179], a[140:143], v[224:227], v[176:179]
    s_and_b32 s90, s89, 0x7fff0000
    buffer_load_dwordx4 v[120:123], v46, s[40:43], s65 offen offset:0 nt
    v_mfma_f32_16x16x32_bf16 v[164:167], a[12:15], v[228:231], v[164:167]
    s_andn2_b32 s91, 0xffff0000, s89
    s_bitcmp1_b32 s89, 31
    s_cselect_b32 s83, s90, s91
    v_mfma_f32_16x16x32_bf16 v[168:171], a[44:47], v[228:231], v[168:171]
    s_lshl_b32 s78, s57, 2
    s_add_u32 s78, s78, s58
    v_mfma_f32_16x16x32_bf16 v[172:175], a[76:79], v[228:231], v[172:175]
    s_lshl_b32 s78, s78, 7
    buffer_load_dwordx4 v[124:127], v46, s[40:43], s65 offen offset:2048 nt
    v_mfma_f32_16x16x32_bf16 v[176:179], a[108:111], v[228:231], v[176:179]
    s_add_u32 s78, s78, 119808
    v_bfe_u32 v4, v1, 1, 3
    v_mfma_f32_16x16x32_bf16 v[168:171], a[12:15], v[232:235], v[168:171]
    v_and_b32 v5, 1, v1
    v_lshlrev_b32 v5, 2, v5
    v_mfma_f32_16x16x32_bf16 v[172:175], a[44:47], v[232:235], v[172:175]
    v_lshl_add_u32 v4, v4, 4, v5
    v_add_u32 v4, s78, v4
    v_mfma_f32_16x16x32_bf16 v[176:179], a[76:79], v[232:235], v[176:179]
    buffer_load_dwordx4 v[128:131], v46, s[40:43], s66 offen offset:0 nt
    ds_read_b32 v5, v4
    v_mfma_f32_16x16x32_bf16 v[172:175], a[12:15], v[236:239], v[172:175]
    s_lshl_b32 s52, s58, 7
    s_add_u32 s52, s52, 84992
    v_mfma_f32_16x16x32_bf16 v[176:179], a[44:47], v[236:239], v[176:179]
    v_and_b32 v4, 15, v1
    v_lshl_add_u32 v4, v4, 3, s52
    v_mfma_f32_16x16x32_bf16 v[176:179], a[12:15], v[240:243], v[176:179]
    s_mul_i32 s78, s56, 28672
    buffer_load_dwordx4 v[132:135], v46, s[40:43], s66 offen offset:2048 nt
    s_waitcnt lgkmcnt(0)
    v_mfma_f32_16x16x32_bf16 v[148:151], a[16:19], v[180:183], v[148:151]
    ds_read_b128 v[212:215], v13 offset:128
    s_and_b32 s79, s57, 3
    v_mfma_f32_16x16x32_bf16 v[152:155], a[48:51], v[180:183], v[152:155]
    ds_read_b128 v[216:219], v13 offset:640
    s_mul_i32 s79, s79, 7168
    v_mfma_f32_16x16x32_bf16 v[156:159], a[80:83], v[180:183], v[156:159]
    ds_read_b128 v[220:223], v13 offset:1152
    s_add_u32 s78, s78, s79
    v_mfma_f32_16x16x32_bf16 v[160:163], a[112:115], v[180:183], v[160:163]
    ds_read_b128 v[224:227], v13 offset:1664
    s_lshr_b32 s79, s57, 2
    v_mfma_f32_16x16x32_bf16 v[164:167], a[144:147], v[180:183], v[164:167]
    ds_read_b128 v[228:231], v13 offset:2176
    s_lshl_b32 s79, s79, 8
    v_mfma_f32_16x16x32_bf16 v[168:171], a[176:179], v[180:183], v[168:171]
    ds_read_b128 v[232:235], v13 offset:2688
    s_add_u32 s78, s78, s79
    v_mfma_f32_16x16x32_bf16 v[172:175], a[208:211], v[180:183], v[172:175]
    ds_read_b128 v[236:239], v13 offset:3200
    buffer_load_dwordx4 v[136:139], v46, s[40:43], s67 offen offset:0 nt
    v_mfma_f32_16x16x32_bf16 v[176:179], a[240:243], v[180:183], v[176:179]
    ds_read_b128 v[240:243], v13 offset:3712
    s_add_u32 s78, s78, 4325376
    v_mfma_f32_16x16x32_bf16 v[152:155], a[16:19], v[184:187], v[152:155]
    s_cmp_ge_u32 s57, 28
    s_cselect_b32 s53, 0x80000000, s78
    v_mfma_f32_16x16x32_bf16 v[156:159], a[48:51], v[184:187], v[156:159]
    s_waitcnt lgkmcnt(0)
    v_and_b32 v249, 0xffff0000, v5
    v_lshlrev_b32 v248, 16, v5
    v_mfma_f32_16x16x32_bf16 v[160:163], a[80:83], v[184:187], v[160:163]
    v_rcp_f32 v249, v249
    v_mfma_f32_16x16x32_bf16 v[164:167], a[112:115], v[184:187], v[164:167]
LP17:
    s_cbranch_execz LPR
    v_mul_f32 v248, -v248, v249
    ds_write_b64 v4, v[248:249]
    v_mfma_f32_16x16x32_bf16 v[168:171], a[144:147], v[184:187], v[168:171]
    v_mfma_f32_16x16x32_bf16 v[172:175], a[176:179], v[184:187], v[172:175]
    v_mfma_f32_16x16x32_bf16 v[176:179], a[208:211], v[184:187], v[176:179]
    v_mfma_f32_16x16x32_bf16 v[156:159], a[16:19], v[188:191], v[156:159]
    v_mfma_f32_16x16x32_bf16 v[160:163], a[48:51], v[188:191], v[160:163]
    s_waitcnt vmcnt(7)
    v_and_b32 v5, 0xffff0000, v142
    v_lshlrev_b32 v4, 16, v142
    v_mfma_f32_16x16x32_bf16 v[164:167], a[80:83], v[188:191], v[164:167]
    v_rcp_f32 v5, v5
    v_lshlrev_b32 v140, 16, v140
    v_mfma_f32_16x16x32_bf16 v[168:171], a[112:115], v[188:191], v[168:171]
    v_sub_f32 v140, v140, v4
    v_cvt_pk_bf16_f32 v140, v140, v140
    v_mfma_f32_16x16x32_bf16 v[172:175], a[144:147], v[188:191], v[172:175]
    v_and_b32 v140, 0xffff0000, v140
    v_mul_f32 v140, v140, v5
    v_mfma_f32_16x16x32_bf16 v[176:179], a[176:179], v[188:191], v[176:179]
    v_readfirstlane_b32 s54, v142
    v_cvt_pk_bf16_f32 v140, v140, v140
    v_mfma_f32_16x16x32_bf16 v[160:163], a[16:19], v[192:195], v[160:163]
    ds_write_b32 v144, v140 offset:0
    v_and_b32 v5, 0xffff0000, v143
    v_mfma_f32_16x16x32_bf16 v[164:167], a[48:51], v[192:195], v[164:167]
    v_lshlrev_b32 v4, 16, v143
    v_rcp_f32 v5, v5
    v_mfma_f32_16x16x32_bf16 v[168:171], a[80:83], v[192:195], v[168:171]
    v_lshlrev_b32 v141, 16, v141
    v_sub_f32 v141, v141, v4
    v_mfma_f32_16x16x32_bf16 v[172:175], a[112:115], v[192:195], v[172:175]
    v_cvt_pk_bf16_f32 v141, v141, v141
    v_and_b32 v141, 0xffff0000, v141
    v_mfma_f32_16x16x32_bf16 v[176:179], a[144:147], v[192:195], v[176:179]
    v_mul_f32 v141, v141, v5
    v_readfirstlane_b32 s55, v143
    v_mfma_f32_16x16x32_bf16 v[164:167], a[16:19], v[196:199], v[164:167]
    v_cvt_pk_bf16_f32 v141, v141, v141
    ds_write_b32 v144, v141 offset:256
    v_mfma_f32_16x16x32_bf16 v[168:171], a[48:51], v[196:199], v[168:171]
    ds_read_b128 v[16:19], v145 offset:0
    ds_read_b128 v[20:23], v145 offset:16
    v_mfma_f32_16x16x32_bf16 v[172:175], a[80:83], v[196:199], v[172:175]
    ds_read_b128 v[24:27], v145 offset:32
    ds_read_b128 v[28:31], v145 offset:48
    v_mfma_f32_16x16x32_bf16 v[176:179], a[112:115], v[196:199], v[176:179]
    v_mfma_f32_16x16x32_bf16 v[168:171], a[16:19], v[200:203], v[168:171]
    v_mfma_f32_16x16x32_bf16 v[172:175], a[48:51], v[200:203], v[172:175]
    v_mfma_f32_16x16x32_bf16 v[176:179], a[80:83], v[200:203], v[176:179]
    v_mfma_f32_16x16x32_bf16 v[172:175], a[16:19], v[204:207], v[172:175]
    s_waitcnt vmcnt(7) lgkmcnt(0)
    v_and_b32 v248, v16, v244
    v_and_b32 v249, v16, v245
    v_mfma_f32_16x16x32_bf16 v[176:179], a[48:51], v[204:207], v[176:179]
    buffer_load_dword v32, v3, s[4:7], 0 offen offset:0 nt
    v_and_b32 v250, v16, v246
    v_mfma_f32_16x16x32_bf16 v[176:179], a[16:19], v[208:211], v[176:179]
    v_and_b32 v251, v16, v247
    buffer_load_dword v33, v3, s[4:7], 0 offen offset:2048 nt
    s_waitcnt lgkmcnt(0)
    v_mfma_f32_16x16x32_bf16 v[148:151], a[20:23], v[212:215], v[148:151]
    ds_read_b128 v[180:183], v13 offset:64
    v_mfma_f32_16x16x32_bf16 v[252:255], v[248:251], v[48:51], 0
    v_and_b32 v248, v17, v244
    buffer_load_dword v34, v3, s[4:7], s65 offen offset:0 nt
    v_mfma_f32_16x16x32_bf16 v[152:155], a[52:55], v[212:215], v[152:155]
    ds_read_b128 v[184:187], v13 offset:576
    v_and_b32 v249, v17, v245
    v_mfma_f32_16x16x32_bf16 v[156:159], a[84:87], v[212:215], v[156:159]
    ds_read_b128 v[188:191], v13 offset:1088
    v_and_b32 v250, v17, v246
    v_mfma_f32_16x16x32_bf16 v[160:163], a[116:119], v[212:215], v[160:163]
    ds_read_b128 v[192:195], v13 offset:1600
LP18:
    s_cbranch_execz LPR
    buffer_load_dword v35, v3, s[4:7], s65 offen offset:2048 nt
    v_mfma_f32_16x16x32_bf16 v[164:167], a[148:151], v[212:215], v[164:167]
    ds_read_b128 v[196:199], v13 offset:2112
    v_and_b32 v251, v17, v247
    v_mfma_f32_16x16x32_bf16 v[168:171], a[180:183], v[212:215], v[168:171]
    ds_read_b128 v[200:203], v13 offset:2624
    v_mfma_f32_16x16x32_bf16 v[252:255], v[248:251], v[52:55], v[252:255]
    buffer_load_dword v36, v3, s[4:7], s66 offen offset:0 nt
    v_and_b32 v248, v18, v244
    v_mfma_f32_16x16x32_bf16 v[172:175], a[212:215], v[212:215], v[172:175]
    ds_read_b128 v[204:207], v13 offset:3136
    v_and_b32 v249, v18, v245
    v_mfma_f32_16x16x32_bf16 v[176:179], a[244:247], v[212:215], v[176:179]
    ds_read_b128 v[208:211], v13 offset:3648
    buffer_load_dword v37, v3, s[4:7], s66 offen offset:2048 nt
    v_mfma_f32_16x16x32_bf16 v[152:155], a[20:23], v[216:219], v[152:155]
    v_and_b32 v250, v18, v246
    v_and_b32 v251, v18, v247
    v_mfma_f32_16x16x32_bf16 v[156:159], a[52:55], v[216:219], v[156:159]
    buffer_load_dword v38, v3, s[4:7], s67 offen offset:0 nt
    v_mfma_f32_16x16x32_bf16 v[252:255], v[248:251], v[56:59], v[252:255]
    v_and_b32 v248, v19, v244
    buffer_load_dword v39, v3, s[4:7], s67 offen offset:2048 nt
    v_mfma_f32_16x16x32_bf16 v[160:163], a[84:87], v[216:219], v[160:163]
    v_and_b32 v249, v19, v245
    v_and_b32 v250, v19, v246
    v_mfma_f32_16x16x32_bf16 v[164:167], a[116:119], v[216:219], v[164:167]
    buffer_load_dword v40, v3, s[4:7], s68 offen offset:0 nt
    v_and_b32 v251, v19, v247
    v_mfma_f32_16x16x32_bf16 v[168:171], a[148:151], v[216:219], v[168:171]
    v_mfma_f32_16x16x32_bf16 v[172:175], a[180:183], v[216:219], v[172:175]
    v_mfma_f32_16x16x32_bf16 v[252:255], v[248:251], v[60:63], v[252:255]
    buffer_load_dword v41, v3, s[4:7], s68 offen offset:2048 nt
    v_and_b32 v248, v20, v244
    v_mfma_f32_16x16x32_bf16 v[176:179], a[212:215], v[216:219], v[176:179]
    v_and_b32 v249, v20, v245
    buffer_load_dword v42, v3, s[4:7], s69 offen offset:0 nt
    v_mfma_f32_16x16x32_bf16 v[156:159], a[20:23], v[220:223], v[156:159]
    v_and_b32 v250, v20, v246
    v_and_b32 v251, v20, v247
    v_mfma_f32_16x16x32_bf16 v[160:163], a[52:55], v[220:223], v[160:163]
    buffer_load_dword v43, v3, s[4:7], s69 offen offset:2048 nt
    v_mfma_f32_16x16x32_bf16 v[252:255], v[248:251], v[64:67], v[252:255]
    v_and_b32 v248, v21, v244
    buffer_load_dword v44, v3, s[4:7], s70 offen offset:0 nt
    v_mfma_f32_16x16x32_bf16 v[164:167], a[84:87], v[220:223], v[164:167]
    v_and_b32 v249, v21, v245
    v_and_b32 v250, v21, v246
    v_mfma_f32_16x16x32_bf16 v[168:171], a[116:119], v[220:223], v[168:171]
    buffer_load_dword v45, v3, s[4:7], s70 offen offset:2048 nt
    v_and_b32 v251, v21, v247
    v_mfma_f32_16x16x32_bf16 v[172:175], a[148:151], v[220:223], v[172:175]
    v_mfma_f32_16x16x32_bf16 v[176:179], a[180:183], v[220:223], v[176:179]
    v_mfma_f32_16x16x32_bf16 v[252:255], v[248:251], v[68:71], v[252:255]
    buffer_load_dword v46, v3, s[4:7], s71 offen offset:0 nt
    v_and_b32 v248, v22, v244
    v_mfma_f32_16x16x32_bf16 v[160:163], a[20:23], v[224:227], v[160:163]
    v_and_b32 v249, v22, v245
    buffer_load_dword v47, v3, s[4:7], s71 offen offset:2048 nt
    v_mfma_f32_16x16x32_bf16 v[164:167], a[52:55], v[224:227], v[164:167]
    v_and_b32 v250, v22, v246
    v_and_b32 v251, v22, v247
    v_mfma_f32_16x16x32_bf16 v[168:171], a[84:87], v[224:227], v[168:171]
    v_mfma_f32_16x16x32_bf16 v[172:175], a[116:119], v[224:227], v[172:175]
    v_mfma_f32_16x16x32_bf16 v[252:255], v[248:251], v[72:75], v[252:255]
    v_and_b32 v248, v23, v244
    v_and_b32 v249, v23, v245
    v_mfma_f32_16x16x32_bf16 v[176:179], a[148:151], v[224:227], v[176:179]
    v_and_b32 v250, v23, v246
    v_and_b32 v251, v23, v247
    v_mfma_f32_16x16x32_bf16 v[164:167], a[20:23], v[228:231], v[164:167]
    v_mfma_f32_16x16x32_bf16 v[168:171], a[52:55], v[228:231], v[168:171]
    v_mfma_f32_16x16x32_bf16 v[252:255], v[248:251], v[76:79], v[252:255]
    v_and_b32 v248, v24, v244
    v_and_b32 v249, v24, v245
    v_mfma_f32_16x16x32_bf16 v[172:175], a[84:87], v[228:231], v[172:175]
    v_and_b32 v250, v24, v246
    v_and_b32 v251, v24, v247
LP19:
    s_cbranch_execz LPR
    v_mfma_f32_16x16x32_bf16 v[176:179], a[116:119], v[228:231], v[176:179]
    v_mfma_f32_16x16x32_bf16 v[168:171], a[20:23], v[232:235], v[168:171]
    v_mfma_f32_16x16x32_bf16 v[252:255], v[248:251], v[80:83], v[252:255]
    v_and_b32 v248, v25, v244
    v_and_b32 v249, v25, v245
    v_mfma_f32_16x16x32_bf16 v[172:175], a[52:55], v[232:235], v[172:175]
    v_and_b32 v250, v25, v246
    v_and_b32 v251, v25, v247
    v_mfma_f32_16x16x32_bf16 v[176:179], a[84:87], v[232:235], v[176:179]
    v_mfma_f32_16x16x32_bf16 v[172:175], a[20:23], v[236:239], v[172:175]
    v_mfma_f32_16x16x32_bf16 v[252:255], v[248:251], v[84:87], v[252:255]
    v_and_b32 v248, v26, v244
    v_and_b32 v249, v26, v245
    v_mfma_f32_16x16x32_bf16 v[176:179], a[52:55], v[236:239], v[176:179]
    v_and_b32 v250, v26, v246
    v_and_b32 v251, v26, v247
    v_mfma_f32_16x16x32_bf16 v[176:179], a[20:23], v[240:243], v[176:179]
    s_waitcnt lgkmcnt(0)
    v_mfma_f32_16x16x32_bf16 v[148:151], a[24:27], v[180:183], v[148:151]
    ds_read_b128 v[212:215], v13 offset:0
    v_mfma_f32_16x16x32_bf16 v[252:255], v[248:251], v[88:91], v[252:255]
    v_and_b32 v248, v27, v244
    v_and_b32 v249, v27, v245
    v_mfma_f32_16x16x32_bf16 v[152:155], a[56:59], v[180:183], v[152:155]
    ds_read_b128 v[216:219], v13 offset:512
    v_and_b32 v250, v27, v246
    v_mfma_f32_16x16x32_bf16 v[156:159], a[88:91], v[180:183], v[156:159]
    ds_read_b128 v[220:223], v13 offset:1024
    v_and_b32 v251, v27, v247
    v_mfma_f32_16x16x32_bf16 v[160:163], a[120:123], v[180:183], v[160:163]
    ds_read_b128 v[224:227], v13 offset:1536
    v_mfma_f32_16x16x32_bf16 v[252:255], v[248:251], v[92:95], v[252:255]
    v_and_b32 v248, v28, v244
    v_and_b32 v249, v28, v245
    v_mfma_f32_16x16x32_bf16 v[164:167], a[152:155], v[180:183], v[164:167]
    ds_read_b128 v[228:231], v13 offset:2048
    v_and_b32 v250, v28, v246
    v_mfma_f32_16x16x32_bf16 v[168:171], a[184:187], v[180:183], v[168:171]
    ds_read_b128 v[232:235], v13 offset:2560
    v_and_b32 v251, v28, v247
    v_mfma_f32_16x16x32_bf16 v[172:175], a[216:219], v[180:183], v[172:175]
    ds_read_b128 v[236:239], v13 offset:3072
    v_mfma_f32_16x16x32_bf16 v[252:255], v[248:251], v[96:99], v[252:255]
    v_and_b32 v248, v29, v244
    v_and_b32 v249, v29, v245
    v_mfma_f32_16x16x32_bf16 v[176:179], a[248:251], v[180:183], v[176:179]
    ds_read_b128 v[240:243], v13 offset:3584
    v_and_b32 v250, v29, v246
    v_mfma_f32_16x16x32_bf16 v[152:155], a[24:27], v[184:187], v[152:155]
    v_and_b32 v251, v29, v247
    v_mfma_f32_16x16x32_bf16 v[156:159], a[56:59], v[184:187], v[156:159]
    v_mfma_f32_16x16x32_bf16 v[160:163], a[88:91], v[184:187], v[160:163]
    v_mfma_f32_16x16x32_bf16 v[252:255], v[248:251], v[100:103], v[252:255]
    v_and_b32 v248, v30, v244
    v_and_b32 v249, v30, v245
    v_mfma_f32_16x16x32_bf16 v[164:167], a[120:123], v[184:187], v[164:167]
    v_and_b32 v250, v30, v246
    v_and_b32 v251, v30, v247
    v_mfma_f32_16x16x32_bf16 v[168:171], a[152:155], v[184:187], v[168:171]
    v_mfma_f32_16x16x32_bf16 v[172:175], a[184:187], v[184:187], v[172:175]
    v_mfma_f32_16x16x32_bf16 v[252:255], v[248:251], v[104:107], v[252:255]
    v_and_b32 v248, v31, v244
    v_and_b32 v249, v31, v245
    v_mfma_f32_16x16x32_bf16 v[176:179], a[216:219], v[184:187], v[176:179]
    v_and_b32 v250, v31, v246
    v_and_b32 v251, v31, v247
    v_mfma_f32_16x16x32_bf16 v[156:159], a[24:27], v[188:191], v[156:159]
    v_mfma_f32_16x16x32_bf16 v[160:163], a[56:59], v[188:191], v[160:163]
    v_mfma_f32_16x16x32_bf16 v[252:255], v[248:251], v[108:111], v[252:255]
    v_bfe_u32 v6, v1, 3, 1
    v_lshrrev_b32 v5, 5, v1
    v_mfma_f32_16x16x32_bf16 v[164:167], a[88:91], v[188:191], v[164:167]
    v_lshl_add_u32 v6, v6, 1, v5
    v_mul_u32_u24 v6, 1792, v6
    v_mfma_f32_16x16x32_bf16 v[168:171], a[120:123], v[188:191], v[168:171]
    v_and_b32 v5, 7, v1
    v_lshl_add_u32 v6, v5, 5, v6
    v_mfma_f32_16x16x32_bf16 v[172:175], a[152:155], v[188:191], v[172:175]
    v_and_b32 v5, 16, v1
    v_add3_u32 v6, v6, v5, s53
LP20:
    s_cbranch_execz LPR
    v_mfma_f32_16x16x32_bf16 v[176:179], a[184:187], v[188:191], v[176:179]
    s_lshl_b32 s78, s58, 10
    s_add_u32 s78, s78, 136192
    v_mfma_f32_16x16x32_bf16 v[160:163], a[24:27], v[192:195], v[160:163]
    v_lshl_add_u32 v4, v1, 4, s78
    ds_write_b128 v4, v[252:255]
    v_mfma_f32_16x16x32_bf16 v[164:167], a[56:59], v[192:195], v[164:167]
    s_waitcnt lgkmcnt(0)
    s_barrier
    v_lshlrev_b32 v4, 4, v1
    v_mfma_f32_16x16x32_bf16 v[168:171], a[88:91], v[192:195], v[168:171]
    v_add_u32 v4, 136192, v4
    ds_read_b128 v[48:51], v4 offset:0
    v_mfma_f32_16x16x32_bf16 v[172:175], a[120:123], v[192:195], v[172:175]
    ds_read_b128 v[52:55], v4 offset:1024
    ds_read_b128 v[56:59], v4 offset:2048
    v_mfma_f32_16x16x32_bf16 v[176:179], a[152:155], v[192:195], v[176:179]
    ds_read_b128 v[60:63], v4 offset:3072
    v_mfma_f32_16x16x32_bf16 v[164:167], a[24:27], v[196:199], v[164:167]
    v_mfma_f32_16x16x32_bf16 v[168:171], a[56:59], v[196:199], v[168:171]
    v_mfma_f32_16x16x32_bf16 v[172:175], a[88:91], v[196:199], v[172:175]
    s_waitcnt lgkmcnt(0)
    v_add_f32 v48, v48, v52
    v_add_f32 v49, v49, v53
    v_mfma_f32_16x16x32_bf16 v[176:179], a[120:123], v[196:199], v[176:179]
    v_add_f32 v50, v50, v54
    v_add_f32 v51, v51, v55
    v_mfma_f32_16x16x32_bf16 v[168:171], a[24:27], v[200:203], v[168:171]
    v_add_f32 v48, v48, v56
    v_add_f32 v49, v49, v57
    v_mfma_f32_16x16x32_bf16 v[172:175], a[56:59], v[200:203], v[172:175]
    v_add_f32 v50, v50, v58
    v_add_f32 v51, v51, v59
    v_mfma_f32_16x16x32_bf16 v[176:179], a[88:91], v[200:203], v[176:179]
    v_add_f32 v48, v48, v60
    v_add_f32 v49, v49, v61
    v_mfma_f32_16x16x32_bf16 v[172:175], a[24:27], v[204:207], v[172:175]
    v_add_f32 v50, v50, v62
    v_add_f32 v51, v51, v63
    v_mfma_f32_16x16x32_bf16 v[176:179], a[56:59], v[204:207], v[176:179]
    v_bfi_b32 v48, v14, s72, v48
    v_bfi_b32 v49, v14, s73, v49
    v_mfma_f32_16x16x32_bf16 v[176:179], a[24:27], v[208:211], v[176:179]
    v_bfi_b32 v50, v14, s74, v50
    v_bfi_b32 v51, v14, s75, v51
    s_waitcnt lgkmcnt(0)
    v_mfma_f32_16x16x32_bf16 v[148:151], a[28:31], v[212:215], v[148:151]
    s_mov_b64 exec, s[0:1]
    s_cmp_eq_u32 s60, 0
    s_cbranch_scc1 LB12
    buffer_store_dwordx4 v[48:51], v6, s[48:51], 0 offen
LB13:
    s_mov_b64 exec, -1
    v_mfma_f32_16x16x32_bf16 v[152:155], a[60:63], v[212:215], v[152:155]
    v_mfma_f32_16x16x32_bf16 v[156:159], a[92:95], v[212:215], v[156:159]
    v_mfma_f32_16x16x32_bf16 v[160:163], a[124:127], v[212:215], v[160:163]
    v_mfma_f32_16x16x32_bf16 v[164:167], a[156:159], v[212:215], v[164:167]
    v_mfma_f32_16x16x32_bf16 v[168:171], a[188:191], v[212:215], v[168:171]
    v_mfma_f32_16x16x32_bf16 v[172:175], a[220:223], v[212:215], v[172:175]
    v_mfma_f32_16x16x32_bf16 v[176:179], a[252:255], v[212:215], v[176:179]
    v_mfma_f32_16x16x32_bf16 v[152:155], a[28:31], v[216:219], v[152:155]
    v_mfma_f32_16x16x32_bf16 v[156:159], a[60:63], v[216:219], v[156:159]
    v_mfma_f32_16x16x32_bf16 v[160:163], a[92:95], v[216:219], v[160:163]
    v_mfma_f32_16x16x32_bf16 v[164:167], a[124:127], v[216:219], v[164:167]
    v_mfma_f32_16x16x32_bf16 v[168:171], a[156:159], v[216:219], v[168:171]
    v_mfma_f32_16x16x32_bf16 v[172:175], a[188:191], v[216:219], v[172:175]
    v_mfma_f32_16x16x32_bf16 v[176:179], a[220:223], v[216:219], v[176:179]
    s_cmp_eq_u32 s60, 0
    s_cbranch_scc1 LB14
    buffer_load_dwordx4 v[16:19], v147, s[48:51], 0 offen nt
    buffer_load_dwordx4 v[20:23], v147, s[48:51], 0 offen offset:3584 nt
LB15:
    v_mfma_f32_16x16x32_bf16 v[156:159], a[28:31], v[220:223], v[156:159]
    v_mfma_f32_16x16x32_bf16 v[160:163], a[60:63], v[220:223], v[160:163]
    v_cvt_pk_bf16_f32 v180, v148, v149
    v_cvt_pk_bf16_f32 v181, v150, v151
    v_mfma_f32_16x16x32_bf16 v[164:167], a[92:95], v[220:223], v[164:167]
LP21:
    s_cbranch_execz LPR
    v_cvt_pk_bf16_f32 v182, v152, v153
    v_cvt_pk_bf16_f32 v183, v154, v155
    v_mfma_f32_16x16x32_bf16 v[168:171], a[124:127], v[220:223], v[168:171]
    v_mfma_f32_16x16x32_bf16 v[172:175], a[156:159], v[220:223], v[172:175]
    v_cvt_pk_bf16_f32 v184, v156, v157
    v_cvt_pk_bf16_f32 v185, v158, v159
    v_mfma_f32_16x16x32_bf16 v[176:179], a[188:191], v[220:223], v[176:179]
    s_cmp_eq_u32 s60, 0
    s_cbranch_scc1 LB16
    buffer_store_dwordx2 v[180:181], v12, s[48:51], 0 offen offset:0
    buffer_store_dwordx2 v[182:183], v12, s[48:51], 0 offen offset:512
    buffer_store_dwordx2 v[184:185], v12, s[48:51], 0 offen offset:1024
LB17:
    v_mfma_f32_16x16x32_bf16 v[160:163], a[28:31], v[224:227], v[160:163]
    v_mfma_f32_16x16x32_bf16 v[164:167], a[60:63], v[224:227], v[164:167]
    v_mfma_f32_16x16x32_bf16 v[168:171], a[92:95], v[224:227], v[168:171]
    v_mfma_f32_16x16x32_bf16 v[172:175], a[124:127], v[224:227], v[172:175]
    v_mfma_f32_16x16x32_bf16 v[176:179], a[156:159], v[224:227], v[176:179]
    v_mfma_f32_16x16x32_bf16 v[164:167], a[28:31], v[228:231], v[164:167]
    v_mfma_f32_16x16x32_bf16 v[168:171], a[60:63], v[228:231], v[168:171]
    v_mfma_f32_16x16x32_bf16 v[172:175], a[92:95], v[228:231], v[172:175]
    v_mfma_f32_16x16x32_bf16 v[176:179], a[124:127], v[228:231], v[176:179]
    v_cvt_pk_bf16_f32 v186, v160, v161
    v_cvt_pk_bf16_f32 v187, v162, v163
    v_mfma_f32_16x16x32_bf16 v[168:171], a[28:31], v[232:235], v[168:171]
    v_mfma_f32_16x16x32_bf16 v[172:175], a[60:63], v[232:235], v[172:175]
    v_mfma_f32_16x16x32_bf16 v[176:179], a[92:95], v[232:235], v[176:179]
    v_cvt_pk_bf16_f32 v188, v164, v165
    v_cvt_pk_bf16_f32 v189, v166, v167
    v_mfma_f32_16x16x32_bf16 v[172:175], a[28:31], v[236:239], v[172:175]
    s_cmp_eq_u32 s60, 0
    s_cbranch_scc1 LB18
    buffer_store_dwordx2 v[186:187], v12, s[48:51], 0 offen offset:1536
    buffer_store_dwordx2 v[188:189], v12, s[48:51], 0 offen offset:2048
LB19:
    v_mfma_f32_16x16x32_bf16 v[176:179], a[60:63], v[236:239], v[176:179]
    v_mfma_f32_16x16x32_bf16 v[176:179], a[28:31], v[240:243], v[176:179]
    v_mov_b32 v6, s52
    s_mov_b32 s86, 0xbfb8aa3b
    v_cvt_pk_bf16_f32 v190, v168, v169
    v_cvt_pk_bf16_f32 v191, v170, v171
    v_cvt_pk_bf16_f32 v192, v172, v173
    v_cvt_pk_bf16_f32 v193, v174, v175
    s_nop 1
    v_cvt_pk_bf16_f32 v194, v176, v177
    v_cvt_pk_bf16_f32 v195, v178, v179
    s_cmp_eq_u32 s60, 0
    s_cbranch_scc1 LB20
    buffer_store_dwordx2 v[190:191], v12, s[48:51], 0 offen offset:2560
    buffer_store_dwordx2 v[192:193], v12, s[48:51], 0 offen offset:3072
    buffer_store_dwordx2 v[194:195], v12, s[48:51], 0 offen offset:3584
LB21:
    ds_read_b128 v[212:215], v6 offset:0
    ds_read_b128 v[216:219], v6 offset:16
    ds_read_b128 v[220:223], v6 offset:32
    ds_read_b128 v[224:227], v6 offset:48
    ds_read_b128 v[228:231], v6 offset:64
    ds_read_b128 v[232:235], v6 offset:80
    ds_read_b128 v[236:239], v6 offset:96
    ds_read_b128 v[240:243], v6 offset:112
    s_waitcnt vmcnt(11) lgkmcnt(0)
    v_lshlrev_b32 v80, 16, v32
    v_and_b32 v81, 0xffff0000, v32
    v_lshlrev_b32 v82, 16, v33
    v_and_b32 v83, 0xffff0000, v33
    v_pk_fma_f32 v[168:169], v[80:81], v[212:213], v[212:213] op_sel:[0,1,0] op_sel_hi:[1,1,0]
    v_pk_fma_f32 v[172:173], v[82:83], v[214:215], v[214:215] op_sel:[0,1,0] op_sel_hi:[1,1,0]
    v_pk_mul_f32 v[170:171], v[168:169], s[86:87] op_sel_hi:[1,0]
    v_pk_mul_f32 v[174:175], v[172:173], s[86:87] op_sel_hi:[1,0]
    v_exp_f32 v170, v170
    v_exp_f32 v171, v171
    v_pk_mul_f32 v[168:169], v[168:169], v[168:169]
    v_exp_f32 v174, v174
    v_exp_f32 v175, v175
LP22:
    s_cbranch_execz LPR
    v_pk_mul_f32 v[172:173], v[172:173], v[172:173]
    v_pk_add_f32 v[170:171], v[170:171], 1.0 op_sel_hi:[1,0]
    v_pk_add_f32 v[174:175], v[174:175], 1.0 op_sel_hi:[1,0]
    v_rcp_f32 v170, v170
    v_rcp_f32 v171, v171
    v_rcp_f32 v174, v174
    v_rcp_f32 v175, v175
    v_pk_mul_f32 v[48:49], v[168:169], v[170:171]
    v_pk_mul_f32 v[50:51], v[172:173], v[174:175]
    v_lshlrev_b32 v84, 16, v34
    v_and_b32 v85, 0xffff0000, v34
    v_lshlrev_b32 v86, 16, v35
    v_and_b32 v87, 0xffff0000, v35
    v_pk_fma_f32 v[168:169], v[84:85], v[216:217], v[216:217] op_sel:[0,1,0] op_sel_hi:[1,1,0]
    v_pk_fma_f32 v[172:173], v[86:87], v[218:219], v[218:219] op_sel:[0,1,0] op_sel_hi:[1,1,0]
    v_pk_mul_f32 v[170:171], v[168:169], s[86:87] op_sel_hi:[1,0]
    v_pk_mul_f32 v[174:175], v[172:173], s[86:87] op_sel_hi:[1,0]
    v_exp_f32 v170, v170
    v_exp_f32 v171, v171
    v_pk_mul_f32 v[168:169], v[168:169], v[168:169]
    v_exp_f32 v174, v174
    v_exp_f32 v175, v175
    v_pk_mul_f32 v[172:173], v[172:173], v[172:173]
    v_pk_add_f32 v[170:171], v[170:171], 1.0 op_sel_hi:[1,0]
    v_pk_add_f32 v[174:175], v[174:175], 1.0 op_sel_hi:[1,0]
    v_rcp_f32 v170, v170
    v_rcp_f32 v171, v171
    v_rcp_f32 v174, v174
    v_rcp_f32 v175, v175
    v_pk_mul_f32 v[52:53], v[168:169], v[170:171]
    v_pk_mul_f32 v[54:55], v[172:173], v[174:175]
    v_lshlrev_b32 v88, 16, v36
    v_and_b32 v89, 0xffff0000, v36
    v_lshlrev_b32 v90, 16, v37
    v_and_b32 v91, 0xffff0000, v37
    v_pk_fma_f32 v[168:169], v[88:89], v[220:221], v[220:221] op_sel:[0,1,0] op_sel_hi:[1,1,0]
    v_pk_fma_f32 v[172:173], v[90:91], v[222:223], v[222:223] op_sel:[0,1,0] op_sel_hi:[1,1,0]
    v_pk_mul_f32 v[170:171], v[168:169], s[86:87] op_sel_hi:[1,0]
    v_pk_mul_f32 v[174:175], v[172:173], s[86:87] op_sel_hi:[1,0]
    v_exp_f32 v170, v170
    v_exp_f32 v171, v171
    v_pk_mul_f32 v[168:169], v[168:169], v[168:169]
    v_exp_f32 v174, v174
    v_exp_f32 v175, v175
    v_pk_mul_f32 v[172:173], v[172:173], v[172:173]
    v_pk_add_f32 v[170:171], v[170:171], 1.0 op_sel_hi:[1,0]
    v_pk_add_f32 v[174:175], v[174:175], 1.0 op_sel_hi:[1,0]
    v_rcp_f32 v170, v170
    v_rcp_f32 v171, v171
    v_rcp_f32 v174, v174
    v_rcp_f32 v175, v175
    v_pk_mul_f32 v[56:57], v[168:169], v[170:171]
    v_pk_mul_f32 v[58:59], v[172:173], v[174:175]
    s_mov_b32 s62, 0x8000
    s_waitcnt vmcnt(8)
LH2R:
    v_perm_b32 v24, v17, v16, s76
    v_perm_b32 v26, v19, v18, s77
    v_or_b32 v24, v24, v26
    v_perm_b32 v25, v21, v20, s76
    v_perm_b32 v26, v23, v22, s77
    v_or_b32 v25, v25, v26
    v_xor_b32 v24, s59, v24
    v_xor_b32 v25, s59, v25
    v_or_b32 v24, v24, v25
    v_cmp_ne_u32 vcc, 0, v24
    s_cbranch_vccz LH2B
    s_cmp_eq_u32 s60, 0
    s_cbranch_scc1 LB22
    buffer_load_dwordx4 v[16:19], v147, s[48:51], 0 offen nt
    buffer_load_dwordx4 v[20:23], v147, s[48:51], 0 offen offset:3584 nt
LB23:
    s_sub_u32 s62, s62, 1
    s_waitcnt vmcnt(0)
    s_cbranch_scc0 LH2R
LH2B:
    v_and_b32 v16, 0xffffff00, v16
    v_and_b32 v17, 0xffffff00, v17
    v_and_b32 v18, 0xffffff00, v18
    v_and_b32 v19, 0xffffff00, v19
    v_and_b32 v20, 0xffffff00, v20
    v_and_b32 v21, 0xffffff00, v21
    v_and_b32 v22, 0xffffff00, v22
    v_and_b32 v23, 0xffffff00, v23
    v_add_f32_dpp v16, v16, v16 quad_perm:[1,0,3,2] row_mask:0xf bank_mask:0xf
LP23:
    s_cbranch_execz LPR
    v_add_f32_dpp v17, v17, v17 quad_perm:[1,0,3,2] row_mask:0xf bank_mask:0xf
    v_add_f32_dpp v18, v18, v18 quad_perm:[1,0,3,2] row_mask:0xf bank_mask:0xf
    v_add_f32_dpp v19, v19, v19 quad_perm:[1,0,3,2] row_mask:0xf bank_mask:0xf
    v_add_f32_dpp v20, v20, v20 quad_perm:[1,0,3,2] row_mask:0xf bank_mask:0xf
    v_add_f32_dpp v21, v21, v21 quad_perm:[1,0,3,2] row_mask:0xf bank_mask:0xf
    v_add_f32_dpp v22, v22, v22 quad_perm:[1,0,3,2] row_mask:0xf bank_mask:0xf
    v_add_f32_dpp v23, v23, v23 quad_perm:[1,0,3,2] row_mask:0xf bank_mask:0xf
    v_add_f32_dpp v16, v16, v16 quad_perm:[2,3,0,1] row_mask:0xf bank_mask:0xf
    v_add_f32_dpp v17, v17, v17 quad_perm:[2,3,0,1] row_mask:0xf bank_mask:0xf
    v_add_f32_dpp v18, v18, v18 quad_perm:[2,3,0,1] row_mask:0xf bank_mask:0xf
    v_add_f32_dpp v19, v19, v19 quad_perm:[2,3,0,1] row_mask:0xf bank_mask:0xf
    v_add_f32_dpp v20, v20, v20 quad_perm:[2,3,0,1] row_mask:0xf bank_mask:0xf
    v_add_f32_dpp v21, v21, v21 quad_perm:[2,3,0,1] row_mask:0xf bank_mask:0xf
    v_add_f32_dpp v22, v22, v22 quad_perm:[2,3,0,1] row_mask:0xf bank_mask:0xf
    v_add_f32_dpp v23, v23, v23 quad_perm:[2,3,0,1] row_mask:0xf bank_mask:0xf
    v_and_b32 v4, 3, v1
    v_cmp_eq_u32 s[88:89], 1, v4
    v_cmp_eq_u32 s[90:91], 2, v4
    v_cmp_eq_u32 s[92:93], 3, v4
    v_cndmask_b32 v16, v16, v17, s[88:89]
    v_cndmask_b32 v20, v20, v21, s[88:89]
    v_cndmask_b32 v16, v16, v18, s[90:91]
    v_cndmask_b32 v20, v20, v22, s[90:91]
    v_cndmask_b32 v16, v16, v19, s[92:93]
    v_cndmask_b32 v20, v20, v23, s[92:93]
    v_cvt_pk_bf16_f32 v16, v16, v16
    v_and_b32 v16, 0xffff0000, v16
    v_cvt_pk_bf16_f32 v20, v20, v20
    v_and_b32 v20, 0xffff0000, v20
    v_mul_f32 v17, 0xbfb8aa3b, v16
    v_exp_f32 v17, v17
    s_nop 0
    v_add_f32 v17, 1.0, v17
    v_rcp_f32 v17, v17
    s_nop 0
    v_mul_f32 v17, v17, v16
    v_cvt_pk_bf16_f32 v17, v17, v17
    v_and_b32 v17, 0xffff0000, v17
    v_mul_f32 v17, v17, v20
    v_cvt_pk_bf16_f32 v17, v17, v17
    ds_bpermute_b32 v148, v2, v17 offset:0
    ds_bpermute_b32 v149, v2, v17 offset:4
    ds_bpermute_b32 v150, v2, v17 offset:8
    ds_bpermute_b32 v151, v2, v17 offset:12
    ds_bpermute_b32 v152, v2, v17 offset:16
    ds_bpermute_b32 v153, v2, v17 offset:20
    ds_bpermute_b32 v154, v2, v17 offset:24
    s_waitcnt lgkmcnt(6)
    v_and_b32 v156, v148, v244
    v_and_b32 v157, v148, v245
    v_and_b32 v158, v148, v246
    v_and_b32 v159, v148, v247
    s_waitcnt lgkmcnt(5)
    v_and_b32 v160, v149, v244
    v_and_b32 v161, v149, v245
    v_and_b32 v162, v149, v246
    v_and_b32 v163, v149, v247
    v_mfma_f32_16x16x32_bf16 v[252:255], v[156:159], v[112:115], 0
    s_waitcnt lgkmcnt(4)
    v_and_b32 v156, v150, v244
    v_and_b32 v157, v150, v245
    v_and_b32 v158, v150, v246
    v_and_b32 v159, v150, v247
    v_mfma_f32_16x16x32_bf16 v[252:255], v[160:163], v[116:119], v[252:255]
    s_waitcnt lgkmcnt(3)
    v_and_b32 v160, v151, v244
    v_and_b32 v161, v151, v245
    v_and_b32 v162, v151, v246
    v_and_b32 v163, v151, v247
    v_mfma_f32_16x16x32_bf16 v[252:255], v[156:159], v[120:123], v[252:255]
    s_waitcnt lgkmcnt(2)
    v_and_b32 v156, v152, v244
    v_and_b32 v157, v152, v245
    v_and_b32 v158, v152, v246
    v_and_b32 v159, v152, v247
    v_mfma_f32_16x16x32_bf16 v[252:255], v[160:163], v[124:127], v[252:255]
    s_waitcnt lgkmcnt(1)
    v_and_b32 v160, v153, v244
    v_and_b32 v161, v153, v245
    v_and_b32 v162, v153, v246
    v_and_b32 v163, v153, v247
    v_mfma_f32_16x16x32_bf16 v[252:255], v[156:159], v[128:131], v[252:255]
    s_waitcnt lgkmcnt(0)
LP24:
    s_cbranch_execz LPR
    v_and_b32 v156, v154, v244
    v_and_b32 v157, v154, v245
    v_and_b32 v158, v154, v246
    v_and_b32 v159, v154, v247
    v_mfma_f32_16x16x32_bf16 v[252:255], v[160:163], v[132:135], v[252:255]
    s_nop 0
    v_mfma_f32_16x16x32_bf16 v[252:255], v[156:159], v[136:139], v[252:255]
    s_lshl_b32 s78, s58, 10
    s_add_u32 s78, s78, 86016
    v_lshl_add_u32 v4, v1, 4, s78
    s_nop 4
    ds_write_b128 v4, v[252:255]
    s_mov_b32 s100, s59
    s_mov_b32 s101, s59
    v_mov_b32 v5, s59
    s_waitcnt vmcnt(0) lgkmcnt(0)
    s_barrier
    s_mov_b64 exec, s[0:1]
    s_cmp_eq_u32 s60, 0
    s_cbranch_scc1 LB24
    buffer_store_dword v5, v7, s[48:51], s68 offen
LB25:
    s_mov_b64 exec, -1
    v_lshlrev_b32 v4, 4, v1
    v_add_u32 v4, 86016, v4
    ds_read_b128 v[196:199], v4 offset:0
    ds_read_b128 v[200:203], v4 offset:1024
    ds_read_b128 v[204:207], v4 offset:2048
    ds_read_b128 v[208:211], v4 offset:3072
    s_or_b32 s78, s2, s58
    s_cmp_lg_u32 s78, 0
    s_cbranch_scc1 LB26
    v_mov_b32 v4, 4849664
    v_mov_b32 v5, s59
    s_mov_b64 exec, 1
    buffer_store_dword v5, v4, s[48:51], 0 offen
    s_mov_b64 exec, -1
LB26:
    s_waitcnt lgkmcnt(0)
    v_add_f32 v196, v196, v200
    v_add_f32 v197, v197, v201
    v_add_f32 v198, v198, v202
    v_add_f32 v199, v199, v203
    v_add_f32 v196, v196, v204
    v_add_f32 v197, v197, v205
    v_add_f32 v198, v198, v206
    v_add_f32 v199, v199, v207
    v_add_f32 v196, v196, v208
    v_add_f32 v197, v197, v209
    v_add_f32 v198, v198, v210
    v_add_f32 v199, v199, v211
    v_bfi_b32 v196, v14, s72, v196
    v_bfi_b32 v197, v14, s73, v197
    v_bfi_b32 v198, v14, s74, v198
    v_bfi_b32 v199, v14, s75, v199
    s_mov_b64 exec, s[0:1]
    buffer_store_dwordx4 v[196:199], v146, s[48:51], 0 offen sc0 sc1
    s_mov_b64 exec, -1
    v_lshlrev_b32 v92, 16, v38
    v_and_b32 v93, 0xffff0000, v38
    v_lshlrev_b32 v94, 16, v39
    v_and_b32 v95, 0xffff0000, v39
    v_pk_fma_f32 v[168:169], v[92:93], v[224:225], v[224:225] op_sel:[0,1,0] op_sel_hi:[1,1,0]
    v_pk_fma_f32 v[172:173], v[94:95], v[226:227], v[226:227] op_sel:[0,1,0] op_sel_hi:[1,1,0]
    v_pk_mul_f32 v[170:171], v[168:169], s[86:87] op_sel_hi:[1,0]
    v_pk_mul_f32 v[174:175], v[172:173], s[86:87] op_sel_hi:[1,0]
    v_exp_f32 v170, v170
    v_exp_f32 v171, v171
    v_pk_mul_f32 v[168:169], v[168:169], v[168:169]
    v_exp_f32 v174, v174
    v_exp_f32 v175, v175
    v_pk_mul_f32 v[172:173], v[172:173], v[172:173]
    v_pk_add_f32 v[170:171], v[170:171], 1.0 op_sel_hi:[1,0]
    v_pk_add_f32 v[174:175], v[174:175], 1.0 op_sel_hi:[1,0]
    v_rcp_f32 v170, v170
    v_rcp_f32 v171, v171
    v_rcp_f32 v174, v174
    v_rcp_f32 v175, v175
    v_pk_mul_f32 v[60:61], v[168:169], v[170:171]
    v_pk_mul_f32 v[62:63], v[172:173], v[174:175]
    s_cmp_eq_u32 s60, 0
    s_cbranch_scc1 LB27
    s_add_u32 s78, s3, 16384
    s_mov_b32 s62, 15
LB29:
    s_load_dwordx8 s[88:95], s[48:49], s78
    s_waitcnt lgkmcnt(0)
    s_cmp_eq_u64 s[88:89], s[100:101]
    s_cbranch_scc0 LB30
    s_cmp_eq_u64 s[90:91], s[100:101]
    s_cbranch_scc0 LB30
    s_cmp_eq_u64 s[92:93], s[100:101]
    s_cbranch_scc0 LB30
    s_cmp_eq_u64 s[94:95], s[100:101]
    s_cbranch_scc1 LB31
LB30:
    s_add_u32 s78, s78, 128
    s_sub_u32 s62, s62, 1
LP25:
    s_cbranch_execz LPR
    s_cbranch_scc0 LB29
    s_add_u32 s78, s3, 16384
    s_mov_b32 s62, 32768
LB32:
    s_load_dwordx8 s[88:95], s[48:49], s78 glc
    s_waitcnt lgkmcnt(0)
    s_cmp_eq_u64 s[88:89], s[100:101]
    s_cbranch_scc0 LB33
    s_cmp_eq_u64 s[90:91], s[100:101]
    s_cbranch_scc0 LB33
    s_cmp_eq_u64 s[92:93], s[100:101]
    s_cbranch_scc0 LB33
    s_cmp_eq_u64 s[94:95], s[100:101]
    s_cbranch_scc1 LB31
LB33:
    s_sub_u32 s62, s62, 1
    s_cbranch_scc0 LB32
LB31:
LB28:
    s_waitcnt lgkmcnt(0)
    s_barrier
    s_cmp_eq_u32 s60, 0
    s_cbranch_scc1 LB36
    buffer_load_dwordx4 v[180:183], v8, s[48:51], 0 offen nt
    buffer_load_dwordx4 v[184:187], v8, s[48:51], s96 offen nt
    buffer_load_dwordx4 v[188:191], v8, s[48:51], s97 offen nt
    buffer_load_dwordx4 v[192:195], v8, s[48:51], s98 offen nt
LB37:
    v_lshlrev_b32 v96, 16, v40
    v_and_b32 v97, 0xffff0000, v40
    v_lshlrev_b32 v98, 16, v41
    v_and_b32 v99, 0xffff0000, v41
    v_pk_fma_f32 v[168:169], v[96:97], v[228:229], v[228:229] op_sel:[0,1,0] op_sel_hi:[1,1,0]
    v_pk_fma_f32 v[172:173], v[98:99], v[230:231], v[230:231] op_sel:[0,1,0] op_sel_hi:[1,1,0]
    v_pk_mul_f32 v[170:171], v[168:169], s[86:87] op_sel_hi:[1,0]
    v_pk_mul_f32 v[174:175], v[172:173], s[86:87] op_sel_hi:[1,0]
    v_exp_f32 v170, v170
    v_exp_f32 v171, v171
    v_pk_mul_f32 v[168:169], v[168:169], v[168:169]
    v_exp_f32 v174, v174
    v_exp_f32 v175, v175
    v_pk_mul_f32 v[172:173], v[172:173], v[172:173]
    v_pk_add_f32 v[170:171], v[170:171], 1.0 op_sel_hi:[1,0]
    v_pk_add_f32 v[174:175], v[174:175], 1.0 op_sel_hi:[1,0]
    v_rcp_f32 v170, v170
    v_rcp_f32 v171, v171
    v_rcp_f32 v174, v174
    v_rcp_f32 v175, v175
    v_pk_mul_f32 v[64:65], v[168:169], v[170:171]
    v_pk_mul_f32 v[66:67], v[172:173], v[174:175]
    v_lshlrev_b32 v100, 16, v42
    v_and_b32 v101, 0xffff0000, v42
    v_lshlrev_b32 v102, 16, v43
    v_and_b32 v103, 0xffff0000, v43
    v_pk_fma_f32 v[168:169], v[100:101], v[232:233], v[232:233] op_sel:[0,1,0] op_sel_hi:[1,1,0]
    v_pk_fma_f32 v[172:173], v[102:103], v[234:235], v[234:235] op_sel:[0,1,0] op_sel_hi:[1,1,0]
    v_pk_mul_f32 v[170:171], v[168:169], s[86:87] op_sel_hi:[1,0]
    v_pk_mul_f32 v[174:175], v[172:173], s[86:87] op_sel_hi:[1,0]
    v_exp_f32 v170, v170
    v_exp_f32 v171, v171
    v_pk_mul_f32 v[168:169], v[168:169], v[168:169]
    v_exp_f32 v174, v174
    v_exp_f32 v175, v175
    v_pk_mul_f32 v[172:173], v[172:173], v[172:173]
    v_pk_add_f32 v[170:171], v[170:171], 1.0 op_sel_hi:[1,0]
    v_pk_add_f32 v[174:175], v[174:175], 1.0 op_sel_hi:[1,0]
    v_rcp_f32 v170, v170
    v_rcp_f32 v171, v171
    v_rcp_f32 v174, v174
    v_rcp_f32 v175, v175
    v_pk_mul_f32 v[68:69], v[168:169], v[170:171]
    v_pk_mul_f32 v[70:71], v[172:173], v[174:175]
    v_lshlrev_b32 v104, 16, v44
    v_and_b32 v105, 0xffff0000, v44
    v_lshlrev_b32 v106, 16, v45
    v_and_b32 v107, 0xffff0000, v45
    v_pk_fma_f32 v[168:169], v[104:105], v[236:237], v[236:237] op_sel:[0,1,0] op_sel_hi:[1,1,0]
    v_pk_fma_f32 v[172:173], v[106:107], v[238:239], v[238:239] op_sel:[0,1,0] op_sel_hi:[1,1,0]
    v_pk_mul_f32 v[170:171], v[168:169], s[86:87] op_sel_hi:[1,0]
    v_pk_mul_f32 v[174:175], v[172:173], s[86:87] op_sel_hi:[1,0]
    v_exp_f32 v170, v170
    v_exp_f32 v171, v171
    v_pk_mul_f32 v[168:169], v[168:169], v[168:169]
    v_exp_f32 v174, v174
    v_exp_f32 v175, v175
    v_pk_mul_f32 v[172:173], v[172:173], v[172:173]
    v_pk_add_f32 v[170:171], v[170:171], 1.0 op_sel_hi:[1,0]
    v_pk_add_f32 v[174:175], v[174:175], 1.0 op_sel_hi:[1,0]
    v_rcp_f32 v170, v170
    v_rcp_f32 v171, v171
    v_rcp_f32 v174, v174
LP26:
    s_cbranch_execz LPR
    v_rcp_f32 v175, v175
    v_pk_mul_f32 v[72:73], v[168:169], v[170:171]
    v_pk_mul_f32 v[74:75], v[172:173], v[174:175]
    v_lshlrev_b32 v108, 16, v46
    v_and_b32 v109, 0xffff0000, v46
    v_lshlrev_b32 v110, 16, v47
    v_and_b32 v111, 0xffff0000, v47
    v_pk_fma_f32 v[168:169], v[108:109], v[240:241], v[240:241] op_sel:[0,1,0] op_sel_hi:[1,1,0]
    v_pk_fma_f32 v[172:173], v[110:111], v[242:243], v[242:243] op_sel:[0,1,0] op_sel_hi:[1,1,0]
    v_pk_mul_f32 v[170:171], v[168:169], s[86:87] op_sel_hi:[1,0]
    v_pk_mul_f32 v[174:175], v[172:173], s[86:87] op_sel_hi:[1,0]
    v_exp_f32 v170, v170
    v_exp_f32 v171, v171
    v_pk_mul_f32 v[168:169], v[168:169], v[168:169]
    v_exp_f32 v174, v174
    v_exp_f32 v175, v175
    v_pk_mul_f32 v[172:173], v[172:173], v[172:173]
    v_pk_add_f32 v[170:171], v[170:171], 1.0 op_sel_hi:[1,0]
    v_pk_add_f32 v[174:175], v[174:175], 1.0 op_sel_hi:[1,0]
    v_rcp_f32 v170, v170
    v_rcp_f32 v171, v171
    v_rcp_f32 v174, v174
    v_rcp_f32 v175, v175
    v_pk_mul_f32 v[76:77], v[168:169], v[170:171]
    v_pk_mul_f32 v[78:79], v[172:173], v[174:175]
    s_waitcnt vmcnt(3)
    ds_write_b128 v9, v[180:183] offset:17408
    s_waitcnt vmcnt(2)
    ds_write_b128 v9, v[184:187] offset:21760
    s_waitcnt vmcnt(1)
    ds_write_b128 v9, v[188:191] offset:26112
    s_waitcnt vmcnt(0)
    ds_write_b128 v9, v[192:195] offset:30464
    s_lshr_b32 s78, s80, 6
    s_cmp_eq_u32 s78, s57
    s_cselect_b32 s92, 1, 0
    s_lshr_b32 s78, s81, 6
    s_cmp_eq_u32 s78, s57
    s_cselect_b32 s93, 2, 0
    s_or_b32 s92, s92, s93
    s_cbranch_scc0 LNO
    s_bitcmp1_b32 s92, 0
    s_cselect_b32 s80, s80, s81
    s_cselect_b32 s82, s82, s83
    s_cselect_b32 s54, s54, s55
    s_cselect_b32 s93, 0, 0x4000
    s_lshl_b32 s78, s56, 15
    s_add_u32 s78, s78, s93
    s_add_u32 s78, s78, 4587520
    v_lshl_add_u32 v129, v0, 4, s78
    s_lshl_b32 s78, s56, 8
    s_lshl_b32 s79, s80, 11
    s_add_u32 s78, s78, s79
    v_lshl_add_u32 v130, v1, 2, s78
    buffer_load_dword v128, v130, s[4:7], 0 offen
    buffer_load_dwordx4 v[112:115], v129, s[48:51], 0 offen sc0 sc1
    buffer_load_dwordx4 v[116:119], v129, s[48:51], s65 offen sc0 sc1
    buffer_load_dwordx4 v[120:123], v129, s[48:51], s66 offen sc0 sc1
    buffer_load_dwordx4 v[124:127], v129, s[48:51], s67 offen sc0 sc1
LNO:
    s_waitcnt lgkmcnt(0)
    s_barrier
    ds_read_b128 v[164:167], v10 offset:17408
    ds_read_b128 v[172:175], v10 offset:17536
    ds_read_b128 v[168:171], v10 offset:17424
    ds_read_b128 v[176:179], v10 offset:17552
    s_waitcnt lgkmcnt(2)
    v_lshlrev_b32 v180, 16, v164
    v_lshlrev_b32 v181, 16, v172
    v_pk_fma_f32 v[180:181], v[180:181], v[48:49], v[80:81]
    v_cvt_pk_bf16_f32 v180, v180, v181
    buffer_store_dword v180, v3, s[44:47], 0 offen offset:0
    v_and_b32 v182, 0xffff0000, v164
    v_and_b32 v183, 0xffff0000, v172
    v_pk_fma_f32 v[182:183], v[182:183], v[50:51], v[82:83]
    v_cvt_pk_bf16_f32 v182, v182, v183
    buffer_store_dword v182, v3, s[44:47], 0 offen offset:2048
    v_lshlrev_b32 v184, 16, v165
    v_lshlrev_b32 v185, 16, v173
    v_pk_fma_f32 v[184:185], v[184:185], v[52:53], v[84:85]
    v_cvt_pk_bf16_f32 v184, v184, v185
    buffer_store_dword v184, v3, s[44:47], s65 offen offset:0
    v_and_b32 v186, 0xffff0000, v165
    v_and_b32 v187, 0xffff0000, v173
LP27:
    s_cbranch_execz LPR
    v_pk_fma_f32 v[186:187], v[186:187], v[54:55], v[86:87]
    v_cvt_pk_bf16_f32 v186, v186, v187
    buffer_store_dword v186, v3, s[44:47], s65 offen offset:2048
    v_lshlrev_b32 v188, 16, v166
    v_lshlrev_b32 v189, 16, v174
    v_pk_fma_f32 v[188:189], v[188:189], v[56:57], v[88:89]
    v_cvt_pk_bf16_f32 v188, v188, v189
    buffer_store_dword v188, v3, s[44:47], s66 offen offset:0
    v_and_b32 v190, 0xffff0000, v166
    v_and_b32 v191, 0xffff0000, v174
    v_pk_fma_f32 v[190:191], v[190:191], v[58:59], v[90:91]
    v_cvt_pk_bf16_f32 v190, v190, v191
    buffer_store_dword v190, v3, s[44:47], s66 offen offset:2048
    v_lshlrev_b32 v192, 16, v167
    v_lshlrev_b32 v193, 16, v175
    v_pk_fma_f32 v[192:193], v[192:193], v[60:61], v[92:93]
    v_cvt_pk_bf16_f32 v192, v192, v193
    buffer_store_dword v192, v3, s[44:47], s67 offen offset:0
    v_and_b32 v194, 0xffff0000, v167
    v_and_b32 v195, 0xffff0000, v175
    v_pk_fma_f32 v[194:195], v[194:195], v[62:63], v[94:95]
    v_cvt_pk_bf16_f32 v194, v194, v195
    buffer_store_dword v194, v3, s[44:47], s67 offen offset:2048
    s_waitcnt lgkmcnt(0)
    v_lshlrev_b32 v196, 16, v168
    v_lshlrev_b32 v197, 16, v176
    v_pk_fma_f32 v[196:197], v[196:197], v[64:65], v[96:97]
    v_cvt_pk_bf16_f32 v196, v196, v197
    buffer_store_dword v196, v3, s[44:47], s68 offen offset:0
    v_and_b32 v198, 0xffff0000, v168
    v_and_b32 v199, 0xffff0000, v176
    v_pk_fma_f32 v[198:199], v[198:199], v[66:67], v[98:99]
    v_cvt_pk_bf16_f32 v198, v198, v199
    buffer_store_dword v198, v3, s[44:47], s68 offen offset:2048
    v_lshlrev_b32 v200, 16, v169
    v_lshlrev_b32 v201, 16, v177
    v_pk_fma_f32 v[200:201], v[200:201], v[68:69], v[100:101]
    v_cvt_pk_bf16_f32 v200, v200, v201
    buffer_store_dword v200, v3, s[44:47], s69 offen offset:0
    v_and_b32 v202, 0xffff0000, v169
    v_and_b32 v203, 0xffff0000, v177
    v_pk_fma_f32 v[202:203], v[202:203], v[70:71], v[102:103]
    v_cvt_pk_bf16_f32 v202, v202, v203
    buffer_store_dword v202, v3, s[44:47], s69 offen offset:2048
    v_lshlrev_b32 v204, 16, v170
    v_lshlrev_b32 v205, 16, v178
    v_pk_fma_f32 v[204:205], v[204:205], v[72:73], v[104:105]
    v_cvt_pk_bf16_f32 v204, v204, v205
    buffer_store_dword v204, v3, s[44:47], s70 offen offset:0
    v_and_b32 v206, 0xffff0000, v170
    v_and_b32 v207, 0xffff0000, v178
    v_pk_fma_f32 v[206:207], v[206:207], v[74:75], v[106:107]
    v_cvt_pk_bf16_f32 v206, v206, v207
    buffer_store_dword v206, v3, s[44:47], s70 offen offset:2048
    v_lshlrev_b32 v208, 16, v171
    v_lshlrev_b32 v209, 16, v179
    v_pk_fma_f32 v[208:209], v[208:209], v[76:77], v[108:109]
    v_cvt_pk_bf16_f32 v208, v208, v209
    buffer_store_dword v208, v3, s[44:47], s71 offen offset:0
    v_and_b32 v210, 0xffff0000, v171
    v_and_b32 v211, 0xffff0000, v179
    v_pk_fma_f32 v[210:211], v[210:211], v[78:79], v[110:111]
    v_cvt_pk_bf16_f32 v210, v210, v211
    buffer_store_dword v210, v3, s[44:47], s71 offen offset:2048
    s_cmp_eq_u32 s92, 0
    s_cbranch_scc0 LFIN
    s_endpgm
LFIN:
    s_and_b32 s78, s80, 63
    s_lshl_b32 s78, s78, 1
    s_add_u32 s78, s78, 102400
    v_mul_u32_u24 v5, 272, v1
    v_add_u32 v5, s78, v5
    ds_read_u16 v156, v5
LP28:
    s_cbranch_execz LPR
    ds_read_u16 v157, v5 offset:128
    v_mov_b32 v158, s82
    v_mul_f32 v158, s86, v158
    s_lshl_b32 s78, s54, 16
    v_exp_f32 v158, v158
    s_and_b32 s79, s54, 0xffff0000
    v_rcp_f32 v159, s79
    v_add_f32 v158, 1.0, v158
    s_mov_b32 s62, 0x8000
    v_rcp_f32 v158, v158
    v_lshlrev_b32 v4, 4, v0
    s_waitcnt vmcnt(16)
LFR:
    v_perm_b32 v164, v113, v112, s76
    v_perm_b32 v168, v115, v114, s77
    v_or_b32 v164, v164, v168
    v_xor_b32 v164, s59, v164
    v_perm_b32 v165, v117, v116, s76
    v_perm_b32 v168, v119, v118, s77
    v_or_b32 v165, v165, v168
    v_xor_b32 v165, s59, v165
    v_perm_b32 v166, v121, v120, s76
    v_perm_b32 v168, v123, v122, s77
    v_or_b32 v166, v166, v168
    v_xor_b32 v166, s59, v166
    v_perm_b32 v167, v125, v124, s76
    v_perm_b32 v168, v127, v126, s77
    v_or_b32 v167, v167, v168
    v_xor_b32 v167, s59, v167
    v_or3_b32 v164, v164, v165, v166
    v_or_b32 v164, v164, v167
    v_cmp_ne_u32 vcc, 0, v164
    s_cbranch_vccz LFB
    buffer_load_dwordx4 v[112:115], v129, s[48:51], 0 offen sc0 sc1
    buffer_load_dwordx4 v[116:119], v129, s[48:51], s65 offen sc0 sc1
    buffer_load_dwordx4 v[120:123], v129, s[48:51], s66 offen sc0 sc1
    buffer_load_dwordx4 v[124:127], v129, s[48:51], s67 offen sc0 sc1
    s_sub_u32 s62, s62, 1
    s_waitcnt vmcnt(0)
    s_cbranch_scc0 LFR
LFB:
    v_and_b32 v112, 0xffffff00, v112
    v_and_b32 v113, 0xffffff00, v113
    v_and_b32 v114, 0xffffff00, v114
    v_and_b32 v115, 0xffffff00, v115
    v_and_b32 v116, 0xffffff00, v116
    v_and_b32 v117, 0xffffff00, v117
    v_and_b32 v118, 0xffffff00, v118
    v_and_b32 v119, 0xffffff00, v119
    v_and_b32 v120, 0xffffff00, v120
    v_and_b32 v121, 0xffffff00, v121
    v_and_b32 v122, 0xffffff00, v122
    v_and_b32 v123, 0xffffff00, v123
    v_and_b32 v124, 0xffffff00, v124
    v_and_b32 v125, 0xffffff00, v125
    v_and_b32 v126, 0xffffff00, v126
    v_and_b32 v127, 0xffffff00, v127
    v_pk_add_f32 v[112:113], v[112:113], v[116:117]
    v_pk_add_f32 v[114:115], v[114:115], v[118:119]
    v_pk_add_f32 v[112:113], v[112:113], v[120:121]
    v_pk_add_f32 v[114:115], v[114:115], v[122:123]
    v_pk_add_f32 v[112:113], v[112:113], v[124:125]
    v_pk_add_f32 v[114:115], v[114:115], v[126:127]
    ds_write_b128 v4, v[112:115] offset:4096
    v_lshlrev_b32 v4, 3, v1
    v_cvt_pk_bf16_f32 v158, v158, v158
    v_and_b32 v158, 0xffff0000, v158
    v_lshlrev_b32 v162, 16, v128
    v_and_b32 v163, 0xffff0000, v128
    v_subrev_f32 v160, s78, v162
    v_subrev_f32 v161, s78, v163
    v_cvt_pk_bf16_f32 v161, v160, v161
    v_lshlrev_b32 v160, 16, v161
    v_and_b32 v161, 0xffff0000, v161
    v_mul_f32 v160, v160, v159
    v_mul_f32 v161, v161, v159
    v_cvt_pk_bf16_f32 v161, v160, v161
    v_lshlrev_b32 v160, 16, v161
    v_and_b32 v161, 0xffff0000, v161
    s_bfe_u32 s78, s80, 0x20004
    s_cmp_lg_u32 s78, s58
    s_waitcnt lgkmcnt(0)
LP29:
    s_cbranch_execz LPR
    s_barrier
    s_cbranch_scc1 LFD
    ds_read_b64 v[132:133], v4 offset:4096
    ds_read_b64 v[134:135], v4 offset:4608
    ds_read_b64 v[136:137], v4 offset:5120
    ds_read_b64 v[138:139], v4 offset:5632
    ds_read_b64 v[140:141], v4 offset:6144
    ds_read_b64 v[142:143], v4 offset:6656
    ds_read_b64 v[144:145], v4 offset:7168
    ds_read_b64 v[146:147], v4 offset:7680
    v_lshlrev_b32 v156, 16, v156
    v_lshlrev_b32 v157, 16, v157
    v_pk_mul_f32 v[156:157], v[156:157], v[160:161]
    v_cvt_pk_bf16_f32 v157, v156, v157
    v_lshlrev_b32 v156, 16, v157
    v_and_b32 v157, 0xffff0000, v157
    s_waitcnt lgkmcnt(6)
    v_pk_add_f32 v[132:133], v[132:133], v[134:135]
    s_waitcnt lgkmcnt(5)
    v_pk_add_f32 v[132:133], v[132:133], v[136:137]
    s_waitcnt lgkmcnt(4)
    v_pk_add_f32 v[132:133], v[132:133], v[138:139]
    s_waitcnt lgkmcnt(3)
    v_pk_add_f32 v[132:133], v[132:133], v[140:141]
    s_waitcnt lgkmcnt(2)
    v_pk_add_f32 v[132:133], v[132:133], v[142:143]
    s_waitcnt lgkmcnt(1)
    v_pk_add_f32 v[132:133], v[132:133], v[144:145]
    s_waitcnt lgkmcnt(0)
    v_pk_add_f32 v[132:133], v[132:133], v[146:147]
    v_cvt_pk_bf16_f32 v133, v132, v133
    v_lshlrev_b32 v132, 16, v133
    v_and_b32 v133, 0xffff0000, v133
    v_pk_mul_f32 v[132:133], v[132:133], v[158:159] op_sel_hi:[1,0]
    v_cvt_pk_bf16_f32 v133, v132, v133
    v_lshlrev_b32 v132, 16, v133
    v_and_b32 v133, 0xffff0000, v133
    v_pk_add_f32 v[132:133], v[132:133], v[160:161]
    v_cvt_pk_bf16_f32 v133, v132, v133
    v_lshlrev_b32 v132, 16, v133
    v_and_b32 v133, 0xffff0000, v133
    v_pk_mul_f32 v[134:135], v[132:133], s[86:87] op_sel_hi:[1,0]
    v_exp_f32 v134, v134
    v_exp_f32 v135, v135
    s_nop 0
    v_pk_add_f32 v[134:135], v[134:135], 1.0 op_sel_hi:[1,0]
    v_rcp_f32 v134, v134
    v_rcp_f32 v135, v135
    s_nop 0
    v_pk_mul_f32 v[134:135], v[134:135], v[132:133]
    v_cvt_pk_bf16_f32 v135, v134, v135
    v_lshlrev_b32 v134, 16, v135
    v_and_b32 v135, 0xffff0000, v135
    v_pk_mul_f32 v[156:157], v[156:157], v[134:135]
    v_cvt_pk_bf16_f32 v157, v156, v157
    v_lshlrev_b32 v156, 16, v157
    v_and_b32 v157, 0xffff0000, v157
    v_pk_add_f32 v[156:157], v[156:157], v[162:163]
    v_cvt_pk_bf16_f32 v156, v156, v157
    buffer_store_dword v156, v130, s[44:47], 0 offen
LFD:
    s_cmp_eq_u32 s92, 3
    s_cbranch_scc1 LF2
LPROF:
LPE:
    s_endpgm
LSLOW:
    s_lshl_b32 s78, s56, 11
    s_add_u32 s78, s78, 4259840
    v_and_b32 v233, 31, v1
    v_lshl_add_u32 v233, v233, 2, s78
    s_lshl_b32 s78, s56, 7
    s_add_u32 s78, s78, 4292608
    v_and_b32 v232, 31, v1
    v_lshl_add_u32 v232, v232, 2, s78
    s_lshl_b32 s79, s57, 2
    s_add_u32 s79, s79, s78
    v_mov_b32 v230, s79
    v_mov_b32 v231, s100
    s_mov_b64 exec, 1
    buffer_store_dword v231, v230, s[48:51], 0 offen sc0 sc1
    s_mov_b64 exec, -1
    s_mov_b32 s62, 0x8000
LB1:
    buffer_load_dword v234, v233, s[48:51], 0 offen sc0 sc1
    buffer_load_dword v235, v232, s[48:51], 0 offen sc0 sc1
    s_waitcnt vmcnt(0)
    v_cmp_ne_u32 vcc, s100, v234
    s_cbranch_vccz LFAST
    v_xor_b32 v235, s100, v235
    v_subrev_u32 v235, 1, v235
    v_cmp_gt_u32 vcc, 15, v235
    s_cbranch_vccnz LB2
    s_sub_u32 s62, s62, 1
    s_cbranch_scc0 LB1
LB2:
    s_mov_b32 s60, 0
    v_add_u32 v8, 0x800000, v8
    v_add_u32 v12, 0x800000, v12
    ds_read_b128 v[96:99], v9 offset:0
    ds_read_b128 v[100:103], v9 offset:4352
    ds_read_b128 v[104:107], v9 offset:8704
    ds_read_b128 v[108:111], v9 offset:13056
    s_waitcnt lgkmcnt(3)
    buffer_store_dwordx4 v[96:99], v8, s[48:51], 0 offen sc0 sc1
    s_waitcnt lgkmcnt(2)
    buffer_store_dwordx4 v[100:103], v8, s[48:51], s96 offen sc0 sc1
    s_waitcnt lgkmcnt(1)
    buffer_store_dwordx4 v[104:107], v8, s[48:51], s97 offen sc0 sc1
    s_waitcnt lgkmcnt(0)
    buffer_store_dwordx4 v[108:111], v8, s[48:51], s98 offen sc0 sc1
    v_mov_b32 v231, s59
    s_waitcnt vmcnt(0)
    s_barrier
    s_mov_b64 exec, 1
    buffer_store_dword v231, v230, s[48:51], 0 offen offset:1024 sc0 sc1
    s_mov_b64 exec, -1
    s_mov_b32 s62, 0x8000
LB3:
    buffer_load_dword v234, v232, s[48:51], 0 offen offset:1024 sc0 sc1
    s_waitcnt vmcnt(0)
    v_cmp_ne_u32 vcc, s59, v234
    s_cbranch_vccz LB4
    s_sub_u32 s62, s62, 1
    s_cbranch_scc0 LB3
LB4:
    buffer_load_dwordx4 v12, s[48:51], 0 offen offset:0 sc0 sc1 lds
    buffer_load_dwordx4 v12, s[48:51], 0 offen offset:1024 sc0 sc1 lds
    buffer_load_dwordx4 v12, s[48:51], 0 offen offset:2048 sc0 sc1 lds
    buffer_load_dwordx4 v12, s[48:51], 0 offen offset:3072 sc0 sc1 lds
    s_branch LJOIN
LFAST:
    buffer_load_dwordx4 v12, s[48:51], 0 offen offset:0 nt lds
    buffer_load_dwordx4 v12, s[48:51], 0 offen offset:1024 nt lds
    buffer_load_dwordx4 v12, s[48:51], 0 offen offset:2048 nt lds
    buffer_load_dwordx4 v12, s[48:51], 0 offen offset:3072 nt lds
    s_branch LJOIN
LRETRY:
    s_mov_b32 s62, 0x8000
LB10:
    buffer_load_dwordx4 v[16:19], v45, s[48:51], 0 offen sc0 sc1
    buffer_load_dwordx4 v[20:23], v45, s[48:51], s65 offen sc0 sc1
    buffer_load_dwordx4 v[24:27], v45, s[48:51], s66 offen sc0 sc1
    buffer_load_dwordx4 v[28:31], v45, s[48:51], s67 offen sc0 sc1
    s_waitcnt vmcnt(0)
    v_xor_b32 v252, s59, v19
    v_xor_b32 v253, s59, v23
    v_xor_b32 v254, s59, v27
    v_xor_b32 v255, s59, v31
    v_or3_b32 v252, v252, v253, v254
    v_or_b32 v252, v252, v255
    v_cmp_ne_u32 vcc, 0, v252
    s_cbranch_vccz LB11
    s_sub_u32 s62, s62, 1
    s_cbranch_scc0 LB10
LB11:
    s_branch LRBACK
LB12:
    buffer_store_dwordx4 v[48:51], v6, s[48:51], 0 offen sc0 sc1
    s_branch LB13
LB14:
    buffer_load_dwordx4 v[16:19], v147, s[48:51], 0 offen sc0 sc1
    buffer_load_dwordx4 v[20:23], v147, s[48:51], 0 offen offset:3584 sc0 sc1
    s_branch LB15
LB16:
    buffer_store_dwordx2 v[180:181], v12, s[48:51], 0 offen offset:0 sc0 sc1
    buffer_store_dwordx2 v[182:183], v12, s[48:51], 0 offen offset:512 sc0 sc1
    buffer_store_dwordx2 v[184:185], v12, s[48:51], 0 offen offset:1024 sc0 sc1
    s_branch LB17
LB18:
    buffer_store_dwordx2 v[186:187], v12, s[48:51], 0 offen offset:1536 sc0 sc1
    buffer_store_dwordx2 v[188:189], v12, s[48:51], 0 offen offset:2048 sc0 sc1
    s_branch LB19
LB20:
    buffer_store_dwordx2 v[190:191], v12, s[48:51], 0 offen offset:2560 sc0 sc1
    buffer_store_dwordx2 v[192:193], v12, s[48:51], 0 offen offset:3072 sc0 sc1
    buffer_store_dwordx2 v[194:195], v12, s[48:51], 0 offen offset:3584 sc0 sc1
    s_branch LB21
LB22:
    buffer_load_dwordx4 v[16:19], v147, s[48:51], 0 offen sc0 sc1
    buffer_load_dwordx4 v[20:23], v147, s[48:51], 0 offen offset:3584 sc0 sc1
    s_branch LB23
LB24:
    buffer_store_dword v5, v7, s[48:51], s68 offen sc0 sc1
    s_branch LB25
LB27:
    s_lshl_b32 s78, s56, 11
    s_add_u32 s78, s78, 4276224
    v_and_b32 v5, 31, v1
    v_lshl_add_u32 v5, v5, 2, s78
    s_mov_b32 s62, 0x8000
LB34:
    buffer_load_dword v4, v5, s[48:51], 0 offen sc0 sc1
    s_waitcnt vmcnt(0)
    v_cmp_ne_u32 vcc, s59, v4
    s_cbranch_vccz LB35
    s_sub_u32 s62, s62, 1
    s_cbranch_scc0 LB34
LB35:
    s_branch LB28
LB36:
    buffer_load_dwordx4 v[180:183], v8, s[48:51], 0 offen sc0 sc1
    buffer_load_dwordx4 v[184:187], v8, s[48:51], s96 offen sc0 sc1
    buffer_load_dwordx4 v[188:191], v8, s[48:51], s97 offen sc0 sc1
    buffer_load_dwordx4 v[192:195], v8, s[48:51], s98 offen sc0 sc1
    s_branch LB37
LF2:
    s_mov_b32 s92, 2
    s_barrier
    s_bitcmp1_b32 s92, 0
    s_cselect_b32 s80, s80, s81
    s_cselect_b32 s82, s82, s83
    s_cselect_b32 s54, s54, s55
    s_cselect_b32 s93, 0, 0x4000
    s_lshl_b32 s78, s56, 15
    s_add_u32 s78, s78, s93
    s_add_u32 s78, s78, 4587520
    v_lshl_add_u32 v129, v0, 4, s78
    s_lshl_b32 s78, s56, 8
    s_lshl_b32 s79, s80, 11
    s_add_u32 s78, s78, s79
    v_lshl_add_u32 v130, v1, 2, s78
    buffer_load_dword v128, v130, s[4:7], 0 offen
    buffer_load_dwordx4 v[112:115], v129, s[48:51], 0 offen sc0 sc1
    buffer_load_dwordx4 v[116:119], v129, s[48:51], s65 offen sc0 sc1
    buffer_load_dwordx4 v[120:123], v129, s[48:51], s66 offen sc0 sc1
    buffer_load_dwordx4 v[124:127], v129, s[48:51], s67 offen sc0 sc1
    s_waitcnt vmcnt(0)
    s_branch LFIN
LEND:
s_endpgm
.section .rodata,"a"
.p2align 6
.amdhsa_kernel recurrent_scan__ssm_conv_h3__moe_arch_mod__prompt_kernel
  .amdhsa_next_free_vgpr 512
  .amdhsa_next_free_sgpr 102
  .amdhsa_accum_offset 256
  .amdhsa_group_segment_fixed_size 0
  .amdhsa_kernarg_size 112
  .amdhsa_user_sgpr_count 2
  .amdhsa_user_sgpr_kernarg_segment_ptr 1
  .amdhsa_system_sgpr_workgroup_id_x 1
.end_amdhsa_kernel
```
